```python
import torch

def _softmax(x, axis=-1):
    return torch.softmax(x, dim=axis)
def _gelu(x):
    return torch.nn.functional.gelu(x, approximate="tanh")
def _silu(x):
    return torch.nn.functional.silu(x)
def _sigmoid(x):
    return torch.sigmoid(x)
def _layernorm(x, axis=-1, eps=1e-5):
    m = x.mean(dim=axis, keepdim=True)
    v = x.var(dim=axis, keepdim=True, unbiased=False)
    return (x - m) / torch.sqrt(v + eps)
def _scatter_add(tgt, idx, src, axis=0):
    return tgt.clone().index_add_(axis, idx, src)
def _segment_sum(src, seg, n):
    out = torch.zeros((n,) + src.shape[1:], dtype=src.dtype)
    return out.index_add_(0, seg, src)
def _pad(x, pw):
    flat = tuple(v for pair in reversed(pw) for v in pair)
    return torch.nn.functional.pad(x, flat)

kernel_name = 'standalone__edge_featured_mpnn_gatedgcn__graph'

def setup_inputs():

    _w = (lambda a: (lambda t: t.to(torch.bfloat16) if t.is_floating_point() else t)(torch.as_tensor(a)))
    N, deg, D, De = 12500, 32, 128, max(4, 1)
    E = N * deg
    return {
        "x": _w((lambda *s: torch.randn(*s, dtype=torch.bfloat16) * 0.4)(N, D)),
        "e_attr": _w((lambda *s: torch.randn(*s, dtype=torch.bfloat16) * 0.8)(E, De)),
        "src": _w((lambda lo, hi, *s: torch.randint(lo, hi, s))(0, N, E).to(torch.int64)),
        "dst": _w((lambda lo, hi, *s: torch.randint(lo, hi, s))(0, N, E).to(torch.int64)),
        "w_a": _w((lambda *s: torch.randn(*s, dtype=torch.bfloat16) * 0.4)(D, D)),
        "w_b": _w((lambda *s: torch.randn(*s, dtype=torch.bfloat16) * 0.4)(D, D)),
        "w_c": _w((lambda *s: torch.randn(*s, dtype=torch.bfloat16) * 0.8)(De, D)),
        "w_u": _w((lambda *s: torch.randn(*s, dtype=torch.bfloat16) * 0.05)(D, D)),
        "w_v": _w((lambda *s: torch.randn(*s, dtype=torch.bfloat16) * 0.05)(D, D)),
    }

def reference(x, e_attr, src, dst, w_a, w_b, w_c, w_u, w_v):
    N, D = x.shape
    hv = x @ w_v
    g = x[dst] @ w_a + x[src] @ w_b + e_attr @ w_c
    eta = _sigmoid(g)
    denom = _segment_sum(eta, dst, N) + 1e-6
    eta_n = eta / denom[dst]
    agg = _segment_sum(eta_n * hv[src], dst, N)
    z = x @ w_u + agg
    relu_z = torch.where(z > 0, z, 0 * z)
    return x + relu_z
```

```asm
; @launch kernel=prep_kernel grid=(256,1,1) block=(1024,1,1) lds=163840
; @launch kernel=agg_kernel grid=(256,1,1) block=(1024,1,1) lds=157696
.amdgcn_target "amdgcn-amd-amdhsa--gfx950"
.text
.globl prep_kernel
.p2align 8
.type prep_kernel,@function
prep_kernel:
    s_cmp_ge_u32 s2, 256
    s_cbranch_scc1 K1_END
    s_cmp_ge_u32 s2, 16
    s_cbranch_scc1 K1_NOCPRE
    s_getpc_b64 s[4:5]
K1_PC:
    v_lshlrev_b32 v2, 7, v0
    v_cmp_gt_u32 vcc, CODE_END-K1_PC, v2
    s_and_saveexec_b64 s[6:7], vcc
    s_cbranch_execz K1_CPRE_DONE
    v_mov_b32 v3, s5
    v_add_co_u32 v2, vcc, s4, v2
    s_nop 1
    v_addc_co_u32 v3, vcc, 0, v3, vcc
    global_load_dword v127, v[2:3], off
K1_CPRE_DONE:
    s_mov_b64 exec, -1
K1_NOCPRE:
    s_load_dwordx2 s[44:45], s[0:1], 88
    v_lshrrev_b32 v2, 6, v0
    v_and_b32 v1, 63, v0
    v_readfirstlane_b32 s50, v2
    s_mov_b32 s46, 17825792
    s_mov_b32 s47, 0x20000
    s_cmp_lt_u32 s2, 128
    s_cbranch_scc1 K1_SORT
    s_load_dwordx2 s[28:29], s[0:1], 0
    s_load_dwordx2 s[32:33], s[0:1], 40
    s_load_dwordx2 s[4:5], s[0:1], 64
    s_load_dwordx2 s[12:13], s[0:1], 32
    s_load_dwordx2 s[18:19], s[0:1], 56
    s_sub_u32 s53, s2, 128
    s_and_b32 s51, s53, 3
    s_lshl_b32 s51, s51, 5
    s_bfe_u32 s52, s53, 0x10002
    s_lshl_b32 s56, s52, 4
    s_add_u32 s51, s51, s56
    s_lshr_b32 s56, s53, 3
    s_add_u32 s51, s51, s56
    s_mul_i32 s54, s51, 25088
    s_add_u32 s58, s54, 25088
    s_min_u32 s30, s58, 3200000
    s_mov_b32 s31, 0x20000
    s_mov_b32 s34, 32768
    s_mov_b32 s35, 0x20000
    s_lshl_b32 s55, s50, 11
    s_add_u32 s56, s54, s55
    s_add_u32 s55, s55, 65536
    s_mov_b32 m0, s55
    v_lshrrev_b32 v6, 4, v1
    v_and_b32 v7, 15, v1
    v_xor_b32 v2, v6, v7
    v_lshlrev_b32 v2, 4, v2
    v_lshl_add_u32 v92, v7, 8, v2
    v_lshl_add_u32 v2, v6, 8, v2
    s_and_b32 s57, s50, 1
    s_lshl_b32 s57, s57, 7
    v_xor_b32 v2, s57, v2
    v_add_u32 v8, s56, v2
    v_xor_b32 v9, 64, v8
    v_lshrrev_b32 v5, 3, v1
    v_lshlrev_b32 v5, 8, v5
    v_bfe_u32 v4, v1, 4, 1
    v_lshlrev_b32 v4, 1, v4
    v_and_b32 v48, 7, v1
    v_xor_b32 v4, v4, v48
    v_lshl_add_u32 v4, v4, 4, v5
    v_xor_b32 v5, 64, v4
    s_lshl_b32 s57, s50, 12
    s_bfe_u32 s59, s50, 0x10002
    s_lshl_b32 s59, s59, 7
    s_and_b32 s56, s50, 3
    s_lshl_b32 s56, s56, 13
    s_add_u32 s24, s59, s56
    s_add_u32 s25, s24, 1024
    s_add_u32 s26, s24, 2048
    s_add_u32 s27, s24, 3072
    s_cmp_lt_u32 s50, 8
    s_waitcnt lgkmcnt(0)
    buffer_load_dwordx4 v8, s[28:31], 0 offen lds
    buffer_load_dwordx4 v9, s[28:31], 0 offen offset:1024 lds
    s_mov_b32 m0, s57
    s_cselect_b64 s[32:33], s[32:33], s[4:5]
    buffer_load_dwordx4 v4, s[32:35], s24 offen offset:0 lds
    buffer_load_dwordx4 v5, s[32:35], s25 offen offset:1024 lds
    buffer_load_dwordx4 v4, s[32:35], s26 offen offset:2048 lds
    buffer_load_dwordx4 v5, s[32:35], s27 offen offset:3072 lds
    s_bfe_u32 s52, s50, 0x10001
    s_lshr_b32 s56, s50, 2
    s_and_b32 s55, s50, 1
    s_mul_i32 s57, s52, 3211264
    s_add_u32 s36, s44, s57
    s_addc_u32 s37, s45, 0
    s_mov_b64 s[38:39], s[30:31]
    v_and_b32 v48, 3, v1
    v_bfe_u32 v49, v1, 3, 2
    v_bfe_u32 v50, v1, 2, 2
    v_lshlrev_b32 v88, 3, v48
    v_lshl_or_b32 v88, v49, 5, v88
    v_lshl_or_b32 v88, v50, 7, v88
    v_lshl_or_b32 v88, v6, 10, v88
    s_lshl_b32 s57, s55, 6
    s_lshl_b32 s59, s52, 14
    s_or_b32 s57, s57, s59
    v_xor_b32 v88, s57, v88
    v_xor_b32 v89, 32, v88
    s_lshl_b32 s57, s56, 13
    s_add_u32 s59, s57, 65536
    v_add_u32 v92, s59, v92
    v_xor_b32 v93, 64, v92
    v_xor_b32 v94, 128, v92
    v_xor_b32 v95, 192, v92
    s_lshl_b32 s59, s50, 12
    s_add_u32 s59, s59, 98304
    v_and_b32 v48, 7, v1
    v_xor_b32 v49, v6, v48
    v_lshlrev_b32 v49, 4, v49
    v_lshl_add_u32 v49, v7, 7, v49
    v_add_u32 v96, s59, v49
    v_xor_b32 v97, 64, v96
    v_lshrrev_b32 v50, 3, v1
    v_xor_b32 v49, v48, v50
    v_lshlrev_b32 v49, 4, v49
    v_lshl_add_u32 v49, v50, 7, v49
    v_add_u32 v98, s59, v49
    s_add_u32 s57, s57, s54
    s_lshl_b32 s59, s55, 7
    s_add_u32 s57, s57, s59
    v_lshlrev_b32 v3, 8, v50
    v_lshl_add_u32 v3, v48, 4, v3
    v_add_u32 v3, s57, v3
    v_add_u32 v7, 4096, v3
    s_mov_b32 s20, 3216550459
    s_mov_b32 s22, 0x05040100
    s_mov_b32 s23, 0x07060302
    s_xor_b32 s51, s51, 16
    s_mul_i32 s51, s51, 25088
    v_lshl_add_u32 v4, v0, 7, s51
    v_lshlrev_b32 v5, 8, v1
    v_mov_b32 v2, 226492416
    s_mov_b32 s30, 3200000
    s_waitcnt vmcnt(0)
    s_barrier
    s_cmp_lt_u32 s50, 4
    s_cbranch_scc0 K1_XPRE_DONE
    s_mov_b64 exec, -1
    s_branch K1_PRE_DONE
K1_XPRE_DONE:
    s_cmp_lt_u32 s53, 8
    s_cbranch_scc0 K1_PRE_DONE
    s_cmp_lt_u32 s50, 8
    s_cbranch_scc0 K1_PRE_DONE
    s_cmp_lt_u32 s50, 6
    s_cselect_b64 s[32:33], s[12:13], s[18:19]
    s_lshl_b32 s57, s55, 14
    s_bfe_u32 s59, s53, 0x10002
    s_lshl_b32 s59, s59, 7
    s_add_u32 s57, s57, s59
    buffer_load_dword v6, v5, s[32:35], s57 offen
K1_PRE_DONE:
    s_cmp_ge_u32 s50, 12
    s_cbranch_scc1 K1_GEMM1
    ds_read_b128 v[8:11], v92 offset:0
    ds_read_b128 v[12:15], v93 offset:0
    ds_read_b128 v[16:19], v94 offset:0
    ds_read_b128 v[20:23], v95 offset:0
    ds_read_b128 v[24:27], v92 offset:4096
    ds_read_b128 v[28:31], v93 offset:4096
    ds_read_b128 v[32:35], v94 offset:4096
    ds_read_b128 v[36:39], v95 offset:4096
    ds_read_b64_tr_b16 v[72:73], v88 offset:0
    ds_read_b64_tr_b16 v[74:75], v88 offset:512
    ds_read_b64_tr_b16 v[76:77], v89 offset:0
    ds_read_b64_tr_b16 v[78:79], v89 offset:512
    ds_read_b64_tr_b16 v[80:81], v88 offset:32768
    ds_read_b64_tr_b16 v[82:83], v88 offset:33280
    ds_read_b64_tr_b16 v[84:85], v89 offset:32768
    ds_read_b64_tr_b16 v[86:87], v89 offset:33280
    s_waitcnt lgkmcnt(4)
    v_mfma_f32_16x16x32_bf16 v[40:43], v[72:75], v[8:11], 0
    v_mfma_f32_16x16x32_bf16 v[56:59], v[72:75], v[24:27], 0
    v_mfma_f32_16x16x32_bf16 v[44:47], v[76:79], v[8:11], 0
    v_mfma_f32_16x16x32_bf16 v[60:63], v[76:79], v[24:27], 0
    ds_read_b64_tr_b16 v[72:73], v88 offset:4096
    ds_read_b64_tr_b16 v[74:75], v88 offset:4608
    ds_read_b64_tr_b16 v[76:77], v89 offset:4096
    ds_read_b64_tr_b16 v[78:79], v89 offset:4608
    s_waitcnt lgkmcnt(4)
    v_mfma_f32_16x16x32_bf16 v[48:51], v[80:83], v[8:11], 0
    v_mfma_f32_16x16x32_bf16 v[64:67], v[80:83], v[24:27], 0
    v_mfma_f32_16x16x32_bf16 v[52:55], v[84:87], v[8:11], 0
    v_mfma_f32_16x16x32_bf16 v[68:71], v[84:87], v[24:27], 0
    ds_read_b64_tr_b16 v[80:81], v88 offset:36864
    ds_read_b64_tr_b16 v[82:83], v88 offset:37376
    ds_read_b64_tr_b16 v[84:85], v89 offset:36864
    ds_read_b64_tr_b16 v[86:87], v89 offset:37376
    s_waitcnt lgkmcnt(4)
    v_mfma_f32_16x16x32_bf16 v[40:43], v[72:75], v[12:15], v[40:43]
    v_mfma_f32_16x16x32_bf16 v[56:59], v[72:75], v[28:31], v[56:59]
    v_mfma_f32_16x16x32_bf16 v[44:47], v[76:79], v[12:15], v[44:47]
    v_mfma_f32_16x16x32_bf16 v[60:63], v[76:79], v[28:31], v[60:63]
    ds_read_b64_tr_b16 v[72:73], v88 offset:8192
    ds_read_b64_tr_b16 v[74:75], v88 offset:8704
    ds_read_b64_tr_b16 v[76:77], v89 offset:8192
    ds_read_b64_tr_b16 v[78:79], v89 offset:8704
    s_waitcnt lgkmcnt(4)
    v_mfma_f32_16x16x32_bf16 v[48:51], v[80:83], v[12:15], v[48:51]
    v_mfma_f32_16x16x32_bf16 v[64:67], v[80:83], v[28:31], v[64:67]
    v_mfma_f32_16x16x32_bf16 v[52:55], v[84:87], v[12:15], v[52:55]
    v_mfma_f32_16x16x32_bf16 v[68:71], v[84:87], v[28:31], v[68:71]
    ds_read_b64_tr_b16 v[80:81], v88 offset:40960
    ds_read_b64_tr_b16 v[82:83], v88 offset:41472
    ds_read_b64_tr_b16 v[84:85], v89 offset:40960
    ds_read_b64_tr_b16 v[86:87], v89 offset:41472
    s_waitcnt lgkmcnt(4)
    v_mfma_f32_16x16x32_bf16 v[40:43], v[72:75], v[16:19], v[40:43]
    v_mfma_f32_16x16x32_bf16 v[56:59], v[72:75], v[32:35], v[56:59]
    v_mfma_f32_16x16x32_bf16 v[44:47], v[76:79], v[16:19], v[44:47]
    v_mfma_f32_16x16x32_bf16 v[60:63], v[76:79], v[32:35], v[60:63]
    ds_read_b64_tr_b16 v[72:73], v88 offset:12288
    ds_read_b64_tr_b16 v[74:75], v88 offset:12800
    ds_read_b64_tr_b16 v[76:77], v89 offset:12288
    ds_read_b64_tr_b16 v[78:79], v89 offset:12800
    s_waitcnt lgkmcnt(4)
    v_mfma_f32_16x16x32_bf16 v[48:51], v[80:83], v[16:19], v[48:51]
    v_mfma_f32_16x16x32_bf16 v[64:67], v[80:83], v[32:35], v[64:67]
    v_mfma_f32_16x16x32_bf16 v[52:55], v[84:87], v[16:19], v[52:55]
    v_mfma_f32_16x16x32_bf16 v[68:71], v[84:87], v[32:35], v[68:71]
    ds_read_b64_tr_b16 v[80:81], v88 offset:45056
    ds_read_b64_tr_b16 v[82:83], v88 offset:45568
    ds_read_b64_tr_b16 v[84:85], v89 offset:45056
    ds_read_b64_tr_b16 v[86:87], v89 offset:45568
    s_waitcnt lgkmcnt(4)
    v_mfma_f32_16x16x32_bf16 v[40:43], v[72:75], v[20:23], v[40:43]
    v_mfma_f32_16x16x32_bf16 v[56:59], v[72:75], v[36:39], v[56:59]
    v_mfma_f32_16x16x32_bf16 v[44:47], v[76:79], v[20:23], v[44:47]
    v_mfma_f32_16x16x32_bf16 v[60:63], v[76:79], v[36:39], v[60:63]
    s_waitcnt lgkmcnt(0)
    v_mfma_f32_16x16x32_bf16 v[48:51], v[80:83], v[20:23], v[48:51]
    v_mfma_f32_16x16x32_bf16 v[64:67], v[80:83], v[36:39], v[64:67]
    v_mfma_f32_16x16x32_bf16 v[52:55], v[84:87], v[20:23], v[52:55]
    v_mfma_f32_16x16x32_bf16 v[68:71], v[84:87], v[36:39], v[68:71]
    v_fma_f32 v40, v40, s20, v2
    v_fma_f32 v41, v41, s20, v2
    s_nop 2
    v_cvt_pk_bf16_f32 v48, v48, v49
    v_sub_u32_sdwa v40, v40, v48 dst_sel:DWORD dst_unused:UNUSED_PAD src0_sel:DWORD src1_sel:WORD_0
    v_sub_u32_sdwa v41, v41, v48 dst_sel:DWORD dst_unused:UNUSED_PAD src0_sel:DWORD src1_sel:WORD_1
    v_cvt_pk_bf16_f32 v40, v40, v41
    v_perm_b32 v8, v40, v48, s22
    v_perm_b32 v9, v40, v48, s23
    v_fma_f32 v42, v42, s20, v2
    v_fma_f32 v43, v43, s20, v2
    v_cvt_pk_bf16_f32 v50, v50, v51
    v_sub_u32_sdwa v42, v42, v50 dst_sel:DWORD dst_unused:UNUSED_PAD src0_sel:DWORD src1_sel:WORD_0
    v_sub_u32_sdwa v43, v43, v50 dst_sel:DWORD dst_unused:UNUSED_PAD src0_sel:DWORD src1_sel:WORD_1
    v_cvt_pk_bf16_f32 v42, v42, v43
    v_perm_b32 v10, v42, v50, s22
    v_perm_b32 v11, v42, v50, s23
    ds_write_b128 v96, v[8:11] offset:0
    v_fma_f32 v44, v44, s20, v2
    v_fma_f32 v45, v45, s20, v2
    v_cvt_pk_bf16_f32 v52, v52, v53
    v_sub_u32_sdwa v44, v44, v52 dst_sel:DWORD dst_unused:UNUSED_PAD src0_sel:DWORD src1_sel:WORD_0
    v_sub_u32_sdwa v45, v45, v52 dst_sel:DWORD dst_unused:UNUSED_PAD src0_sel:DWORD src1_sel:WORD_1
    v_cvt_pk_bf16_f32 v44, v44, v45
    v_perm_b32 v12, v44, v52, s22
    v_perm_b32 v13, v44, v52, s23
    v_fma_f32 v46, v46, s20, v2
    v_fma_f32 v47, v47, s20, v2
    v_cvt_pk_bf16_f32 v54, v54, v55
    v_sub_u32_sdwa v46, v46, v54 dst_sel:DWORD dst_unused:UNUSED_PAD src0_sel:DWORD src1_sel:WORD_0
    v_sub_u32_sdwa v47, v47, v54 dst_sel:DWORD dst_unused:UNUSED_PAD src0_sel:DWORD src1_sel:WORD_1
    v_cvt_pk_bf16_f32 v46, v46, v47
    v_perm_b32 v14, v46, v54, s22
    v_perm_b32 v15, v46, v54, s23
    ds_write_b128 v97, v[12:15] offset:0
    v_fma_f32 v56, v56, s20, v2
    v_fma_f32 v57, v57, s20, v2
    v_cvt_pk_bf16_f32 v64, v64, v65
    v_sub_u32_sdwa v56, v56, v64 dst_sel:DWORD dst_unused:UNUSED_PAD src0_sel:DWORD src1_sel:WORD_0
    v_sub_u32_sdwa v57, v57, v64 dst_sel:DWORD dst_unused:UNUSED_PAD src0_sel:DWORD src1_sel:WORD_1
    v_cvt_pk_bf16_f32 v56, v56, v57
    v_perm_b32 v16, v56, v64, s22
    v_perm_b32 v17, v56, v64, s23
    v_fma_f32 v58, v58, s20, v2
    v_fma_f32 v59, v59, s20, v2
    v_cvt_pk_bf16_f32 v66, v66, v67
    v_sub_u32_sdwa v58, v58, v66 dst_sel:DWORD dst_unused:UNUSED_PAD src0_sel:DWORD src1_sel:WORD_0
    v_sub_u32_sdwa v59, v59, v66 dst_sel:DWORD dst_unused:UNUSED_PAD src0_sel:DWORD src1_sel:WORD_1
    v_cvt_pk_bf16_f32 v58, v58, v59
    v_perm_b32 v18, v58, v66, s22
    v_perm_b32 v19, v58, v66, s23
    ds_write_b128 v96, v[16:19] offset:2048
    v_fma_f32 v60, v60, s20, v2
    v_fma_f32 v61, v61, s20, v2
    v_cvt_pk_bf16_f32 v68, v68, v69
    v_sub_u32_sdwa v60, v60, v68 dst_sel:DWORD dst_unused:UNUSED_PAD src0_sel:DWORD src1_sel:WORD_0
    v_sub_u32_sdwa v61, v61, v68 dst_sel:DWORD dst_unused:UNUSED_PAD src0_sel:DWORD src1_sel:WORD_1
    v_cvt_pk_bf16_f32 v60, v60, v61
    v_perm_b32 v20, v60, v68, s22
    v_perm_b32 v21, v60, v68, s23
    v_fma_f32 v62, v62, s20, v2
    v_fma_f32 v63, v63, s20, v2
    v_cvt_pk_bf16_f32 v70, v70, v71
    v_sub_u32_sdwa v62, v62, v70 dst_sel:DWORD dst_unused:UNUSED_PAD src0_sel:DWORD src1_sel:WORD_0
    v_sub_u32_sdwa v63, v63, v70 dst_sel:DWORD dst_unused:UNUSED_PAD src0_sel:DWORD src1_sel:WORD_1
    v_cvt_pk_bf16_f32 v62, v62, v63
    v_perm_b32 v22, v62, v70, s22
    v_perm_b32 v23, v62, v70, s23
    ds_write_b128 v97, v[20:23] offset:2048
    s_waitcnt lgkmcnt(0)
    ds_read_b128 v[24:27], v98 offset:0
    ds_read_b128 v[28:31], v98 offset:1024
    ds_read_b128 v[32:35], v98 offset:2048
    ds_read_b128 v[36:39], v98 offset:3072
    s_waitcnt lgkmcnt(3)
    buffer_store_dwordx4 v[24:27], v3, s[36:39], 0 offen offset:0 sc1
    s_waitcnt lgkmcnt(2)
    buffer_store_dwordx4 v[28:31], v3, s[36:39], 0 offen offset:2048 sc1
    s_waitcnt lgkmcnt(1)
    buffer_store_dwordx4 v[32:35], v7, s[36:39], 0 offen offset:0 sc1
    s_waitcnt lgkmcnt(0)
    buffer_store_dwordx4 v[36:39], v7, s[36:39], 0 offen offset:2048 sc1
    s_endpgm
K1_GEMM1:
    ds_read_b128 v[8:11], v92 offset:0
    ds_read_b128 v[12:15], v93 offset:0
    ds_read_b128 v[16:19], v94 offset:0
    ds_read_b128 v[20:23], v95 offset:0
    ds_read_b64_tr_b16 v[72:73], v88 offset:0
    ds_read_b64_tr_b16 v[74:75], v88 offset:512
    ds_read_b64_tr_b16 v[76:77], v89 offset:0
    ds_read_b64_tr_b16 v[78:79], v89 offset:512
    ds_read_b64_tr_b16 v[80:81], v88 offset:32768
    ds_read_b64_tr_b16 v[82:83], v88 offset:33280
    ds_read_b64_tr_b16 v[84:85], v89 offset:32768
    ds_read_b64_tr_b16 v[86:87], v89 offset:33280
    s_waitcnt lgkmcnt(4)
    v_mfma_f32_16x16x32_bf16 v[40:43], v[72:75], v[8:11], 0
    v_mfma_f32_16x16x32_bf16 v[44:47], v[76:79], v[8:11], 0
    ds_read_b64_tr_b16 v[72:73], v88 offset:4096
    ds_read_b64_tr_b16 v[74:75], v88 offset:4608
    ds_read_b64_tr_b16 v[76:77], v89 offset:4096
    ds_read_b64_tr_b16 v[78:79], v89 offset:4608
    s_waitcnt lgkmcnt(4)
    v_mfma_f32_16x16x32_bf16 v[48:51], v[80:83], v[8:11], 0
    v_mfma_f32_16x16x32_bf16 v[52:55], v[84:87], v[8:11], 0
    ds_read_b64_tr_b16 v[80:81], v88 offset:36864
    ds_read_b64_tr_b16 v[82:83], v88 offset:37376
    ds_read_b64_tr_b16 v[84:85], v89 offset:36864
    ds_read_b64_tr_b16 v[86:87], v89 offset:37376
    s_waitcnt lgkmcnt(4)
    v_mfma_f32_16x16x32_bf16 v[40:43], v[72:75], v[12:15], v[40:43]
    v_mfma_f32_16x16x32_bf16 v[44:47], v[76:79], v[12:15], v[44:47]
    ds_read_b64_tr_b16 v[72:73], v88 offset:8192
    ds_read_b64_tr_b16 v[74:75], v88 offset:8704
    ds_read_b64_tr_b16 v[76:77], v89 offset:8192
    ds_read_b64_tr_b16 v[78:79], v89 offset:8704
    s_waitcnt lgkmcnt(4)
    v_mfma_f32_16x16x32_bf16 v[48:51], v[80:83], v[12:15], v[48:51]
    v_mfma_f32_16x16x32_bf16 v[52:55], v[84:87], v[12:15], v[52:55]
    ds_read_b64_tr_b16 v[80:81], v88 offset:40960
    ds_read_b64_tr_b16 v[82:83], v88 offset:41472
    ds_read_b64_tr_b16 v[84:85], v89 offset:40960
    ds_read_b64_tr_b16 v[86:87], v89 offset:41472
    s_waitcnt lgkmcnt(4)
    v_mfma_f32_16x16x32_bf16 v[40:43], v[72:75], v[16:19], v[40:43]
    v_mfma_f32_16x16x32_bf16 v[44:47], v[76:79], v[16:19], v[44:47]
    ds_read_b64_tr_b16 v[72:73], v88 offset:12288
    ds_read_b64_tr_b16 v[74:75], v88 offset:12800
    ds_read_b64_tr_b16 v[76:77], v89 offset:12288
    ds_read_b64_tr_b16 v[78:79], v89 offset:12800
    s_waitcnt lgkmcnt(4)
    v_mfma_f32_16x16x32_bf16 v[48:51], v[80:83], v[16:19], v[48:51]
    v_mfma_f32_16x16x32_bf16 v[52:55], v[84:87], v[16:19], v[52:55]
    ds_read_b64_tr_b16 v[80:81], v88 offset:45056
    ds_read_b64_tr_b16 v[82:83], v88 offset:45568
    ds_read_b64_tr_b16 v[84:85], v89 offset:45056
    ds_read_b64_tr_b16 v[86:87], v89 offset:45568
    s_waitcnt lgkmcnt(4)
    v_mfma_f32_16x16x32_bf16 v[40:43], v[72:75], v[20:23], v[40:43]
    v_mfma_f32_16x16x32_bf16 v[44:47], v[76:79], v[20:23], v[44:47]
    s_waitcnt lgkmcnt(0)
    v_mfma_f32_16x16x32_bf16 v[48:51], v[80:83], v[20:23], v[48:51]
    v_mfma_f32_16x16x32_bf16 v[52:55], v[84:87], v[20:23], v[52:55]
    s_nop 3
    v_fma_f32 v40, v40, s20, v2
    v_fma_f32 v41, v41, s20, v2
    s_nop 0
    v_cvt_pk_bf16_f32 v48, v48, v49
    v_sub_u32_sdwa v40, v40, v48 dst_sel:DWORD dst_unused:UNUSED_PAD src0_sel:DWORD src1_sel:WORD_0
    v_sub_u32_sdwa v41, v41, v48 dst_sel:DWORD dst_unused:UNUSED_PAD src0_sel:DWORD src1_sel:WORD_1
    v_cvt_pk_bf16_f32 v40, v40, v41
    v_perm_b32 v8, v40, v48, s22
    v_perm_b32 v9, v40, v48, s23
    v_fma_f32 v42, v42, s20, v2
    v_fma_f32 v43, v43, s20, v2
    v_cvt_pk_bf16_f32 v50, v50, v51
    v_sub_u32_sdwa v42, v42, v50 dst_sel:DWORD dst_unused:UNUSED_PAD src0_sel:DWORD src1_sel:WORD_0
    v_sub_u32_sdwa v43, v43, v50 dst_sel:DWORD dst_unused:UNUSED_PAD src0_sel:DWORD src1_sel:WORD_1
    v_cvt_pk_bf16_f32 v42, v42, v43
    v_perm_b32 v10, v42, v50, s22
    v_perm_b32 v11, v42, v50, s23
    ds_write_b128 v96, v[8:11] offset:0
    v_fma_f32 v44, v44, s20, v2
    v_fma_f32 v45, v45, s20, v2
    v_cvt_pk_bf16_f32 v52, v52, v53
    v_sub_u32_sdwa v44, v44, v52 dst_sel:DWORD dst_unused:UNUSED_PAD src0_sel:DWORD src1_sel:WORD_0
    v_sub_u32_sdwa v45, v45, v52 dst_sel:DWORD dst_unused:UNUSED_PAD src0_sel:DWORD src1_sel:WORD_1
    v_cvt_pk_bf16_f32 v44, v44, v45
    v_perm_b32 v12, v44, v52, s22
    v_perm_b32 v13, v44, v52, s23
    v_fma_f32 v46, v46, s20, v2
    v_fma_f32 v47, v47, s20, v2
    v_cvt_pk_bf16_f32 v54, v54, v55
    v_sub_u32_sdwa v46, v46, v54 dst_sel:DWORD dst_unused:UNUSED_PAD src0_sel:DWORD src1_sel:WORD_0
    v_sub_u32_sdwa v47, v47, v54 dst_sel:DWORD dst_unused:UNUSED_PAD src0_sel:DWORD src1_sel:WORD_1
    v_cvt_pk_bf16_f32 v46, v46, v47
    v_perm_b32 v14, v46, v54, s22
    v_perm_b32 v15, v46, v54, s23
    ds_write_b128 v97, v[12:15] offset:0
    s_waitcnt lgkmcnt(0)
    ds_read_b128 v[24:27], v98 offset:0
    s_waitcnt lgkmcnt(0)
    buffer_store_dwordx4 v[24:27], v3, s[36:39], 0 offen offset:0 sc1
    s_endpgm
K1_SORT:
    s_load_dwordx2 s[28:29], s[0:1], 24
    s_load_dwordx2 s[32:33], s[0:1], 16
    s_load_dwordx2 s[36:37], s[0:1], 8
    s_load_dwordx2 s[16:17], s[0:1], 48
    s_and_b32 s52, s2, 7
    s_lshl_b32 s52, s52, 4
    s_lshr_b32 s51, s2, 3
    s_add_u32 s51, s51, s52
    s_mul_i32 s52, s51, 3128
    v_lshl_add_u32 v2, v0, 2, s52
    s_sub_u32 s58, 400000, s52
    s_min_u32 s58, s58, 3128
    s_lshr_b32 s53, s58, 2
    v_cmp_gt_u32 s[48:49], s53, v0
    v_lshlrev_b32 v4, 3, v2
    v_lshlrev_b32 v2, 2, v2
    s_mul_i32 s42, s58, 12
    s_mov_b32 s43, 0x20000
    s_mov_b32 s30, 1600000
    s_mov_b32 s31, 0x20000
    s_mov_b64 s[34:35], s[30:31]
    s_mov_b32 s38, 3200000
    s_mov_b32 s39, 0x20000
    s_mul_i32 s53, s51, 37536
    s_add_u32 s53, s53, 8388608
    s_mov_b32 s54, 42800
    s_mov_b32 s55, 98
    s_mov_b32 s56, 1024
    v_mov_b32 v5, 12
    v_lshlrev_b32 v6, 3, v1
    v_mov_b32 v40, 0
    v_mov_b32 v41, 0
    ds_write_b64 v6, v[40:41]
    s_mov_b64 exec, s[48:49]
    s_waitcnt lgkmcnt(0)
    buffer_load_dwordx4 v[8:11], v2, s[28:31], 0 offen nt
    s_add_u32 s40, s44, s53
    s_addc_u32 s41, s45, 0
    s_cmp_gt_u32 s50, 12
    s_barrier
    s_cbranch_scc1 K1_IDLE
    buffer_load_dwordx4 v[12:15], v2, s[32:35], 0 offen nt
    buffer_load_dwordx4 v[16:19], v4, s[36:39], 0 offen nt
    buffer_load_dwordx4 v[20:23], v4, s[36:39], 0 offen offset:16 nt
    s_waitcnt vmcnt(3)
    v_mul_u32_u24 v24, s54, v8
    v_lshrrev_b32 v24, 22, v24
    v_mul_u32_u24 v32, s55, v24
    v_lshlrev_b32 v24, 2, v24
    ds_add_rtn_u32 v28, v24, v5
    v_sub_u32 v32, v8, v32
    v_mul_u32_u24 v25, s54, v9
    v_lshrrev_b32 v25, 22, v25
    v_mul_u32_u24 v33, s55, v25
    v_lshlrev_b32 v25, 2, v25
    ds_add_rtn_u32 v29, v25, v5
    v_sub_u32 v33, v9, v33
    v_mul_u32_u24 v26, s54, v10
    v_lshrrev_b32 v26, 22, v26
    v_mul_u32_u24 v34, s55, v26
    v_lshlrev_b32 v26, 2, v26
    ds_add_rtn_u32 v30, v26, v5
    v_sub_u32 v34, v10, v34
    v_mul_u32_u24 v27, s54, v11
    v_lshrrev_b32 v27, 22, v27
    v_mul_u32_u24 v35, s55, v27
    v_lshlrev_b32 v27, 2, v27
    ds_add_rtn_u32 v31, v27, v5
    v_sub_u32 v35, v11, v35
    s_mov_b64 exec, -1
    s_waitcnt lgkmcnt(0)
    s_barrier
    ds_read_b64 v[40:41], v6
    s_waitcnt lgkmcnt(0)
    v_add_u32 v42, v40, v41
    v_add_u32 v43, v40, v41
    s_nop 1
    v_add_u32_dpp v43, v43, v43 row_shr:1 row_mask:0xf bank_mask:0xf bound_ctrl:1
    s_nop 1
    v_add_u32_dpp v43, v43, v43 row_shr:2 row_mask:0xf bank_mask:0xf bound_ctrl:1
    s_nop 1
    v_add_u32_dpp v43, v43, v43 row_shr:4 row_mask:0xf bank_mask:0xf bound_ctrl:1
    s_nop 1
    v_add_u32_dpp v43, v43, v43 row_shr:8 row_mask:0xf bank_mask:0xf bound_ctrl:1
    s_nop 1
    v_add_u32_dpp v43, v43, v43 row_bcast:15 row_mask:0xa bank_mask:0xf
    s_nop 1
    v_add_u32_dpp v43, v43, v43 row_bcast:31 row_mask:0xc bank_mask:0xf
    v_sub_u32 v44, v43, v42
    v_add_u32 v45, v44, v40
    ds_write_b64 v6, v[44:45] offset:512
    s_mov_b64 exec, s[48:49]
    ds_read_b32 v24, v24 offset:512
    ds_read_b32 v25, v25 offset:512
    ds_read_b32 v26, v26 offset:512
    ds_read_b32 v27, v27 offset:512
    s_waitcnt vmcnt(2)
    v_lshl_or_b32 v32, v12, 8, v32
    v_lshl_or_b32 v33, v13, 8, v33
    v_lshl_or_b32 v34, v14, 8, v34
    v_lshl_or_b32 v35, v15, 8, v35
    s_waitcnt lgkmcnt(3)
    v_add3_u32 v28, v24, v28, s56
    ds_write_b32 v28, v32 offset:8
    s_waitcnt lgkmcnt(3)
    v_add3_u32 v29, v25, v29, s56
    ds_write_b32 v29, v33 offset:8
    s_waitcnt lgkmcnt(3)
    v_add3_u32 v30, v26, v30, s56
    ds_write_b32 v30, v34 offset:8
    s_waitcnt lgkmcnt(3)
    v_add3_u32 v31, v27, v31, s56
    ds_write_b32 v31, v35 offset:8
    s_waitcnt vmcnt(1)
    ds_write2_b32 v28, v16, v17 offset0:0 offset1:1
    ds_write2_b32 v29, v18, v19 offset0:0 offset1:1
    s_waitcnt vmcnt(0)
    ds_write2_b32 v30, v20, v21 offset0:0 offset1:1
    ds_write2_b32 v31, v22, v23 offset0:0 offset1:1
    s_mov_b64 exec, -1
K1_NOINFO:
    v_lshlrev_b32 v7, 4, v0
    s_waitcnt lgkmcnt(0)
    s_barrier
    ds_read_b128 v[8:11], v7 offset:1024
    ds_read_b128 v[12:15], v7 offset:17408
    ds_read_b128 v[16:19], v7 offset:33792
    v_add_u32 v41, 16384, v7
    v_add_u32 v42, 32768, v7
    s_waitcnt lgkmcnt(2)
    buffer_store_dwordx4 v[8:11], v7, s[40:43], 0 offen sc1
    s_waitcnt lgkmcnt(1)
    buffer_store_dwordx4 v[12:15], v41, s[40:43], 0 offen sc1
    s_waitcnt lgkmcnt(0)
    buffer_store_dwordx4 v[16:19], v42, s[40:43], 0 offen sc1
K1_END:
    s_endpgm
K1_IDLE:
    s_mov_b64 exec, -1
    s_cmp_eq_u32 s50, 14
    s_cbranch_scc0 K1_AUX
    s_barrier
    ds_read_b64 v[40:41], v6
    s_waitcnt lgkmcnt(0)
    v_add_u32 v42, v40, v41
    v_add_u32 v43, v40, v41
    s_nop 1
    v_add_u32_dpp v43, v43, v43 row_shr:1 row_mask:0xf bank_mask:0xf bound_ctrl:1
    s_nop 1
    v_add_u32_dpp v43, v43, v43 row_shr:2 row_mask:0xf bank_mask:0xf bound_ctrl:1
    s_nop 1
    v_add_u32_dpp v43, v43, v43 row_shr:4 row_mask:0xf bank_mask:0xf bound_ctrl:1
    s_nop 1
    v_add_u32_dpp v43, v43, v43 row_shr:8 row_mask:0xf bank_mask:0xf bound_ctrl:1
    s_nop 1
    v_add_u32_dpp v43, v43, v43 row_bcast:15 row_mask:0xa bank_mask:0xf
    s_nop 1
    v_add_u32_dpp v43, v43, v43 row_bcast:31 row_mask:0xc bank_mask:0xf
    v_sub_u32 v44, v43, v42
    v_add_u32 v45, v44, v40
    s_mov_b32 s53, 43691
    v_mul_u32_u24 v40, s53, v40
    v_mul_u32_u24 v41, s53, v41
    v_lshrrev_b32 v40, 19, v40
    v_lshrrev_b32 v41, 19, v41
    v_lshl_or_b32 v44, v40, 16, v44
    v_lshl_or_b32 v45, v41, 16, v45
    s_lshl_b32 s53, s51, 2
    s_add_u32 s53, s53, 16777216
    v_lshl_add_u32 v7, v1, 10, s53
    buffer_store_dword v44, v7, s[44:47], 0 offen
    buffer_store_dword v45, v7, s[44:47], 0 offen offset:512
    s_branch K1_NOINFO
K1_AUX:
    s_barrier
    s_cmp_eq_u32 s50, 15
    s_cbranch_scc0 K1_NOINFO
    s_cmp_gt_u32 s51, 1
    s_cbranch_scc1 K1_NOINFO
    s_mov_b32 s18, 1024
    s_mov_b32 s19, 0x20000
    v_lshrrev_b32 v10, 4, v1
    v_and_b32 v11, 15, v1
    s_lshl_b32 s53, s51, 7
    v_lshl_add_u32 v12, v11, 3, s53
    v_lshl_add_u32 v12, v10, 1, v12
    buffer_load_ushort v16, v12, s[16:19], 0 offen offset:0
    buffer_load_ushort v17, v12, s[16:19], 0 offen offset:256
    buffer_load_ushort v18, v12, s[16:19], 0 offen offset:512
    buffer_load_ushort v19, v12, s[16:19], 0 offen offset:768
    v_mov_b32 v13, 0x7f000000
    s_mul_i32 s53, s51, 3211264
    s_add_u32 s53, s53, 3200000
    v_lshl_add_u32 v14, v1, 2, s53
    buffer_store_dword v13, v14, s[44:47], 0 offen sc1
    v_and_b32 v12, 3, v1
    v_bfe_u32 v13, v1, 3, 2
    v_bfe_u32 v15, v1, 2, 2
    v_lshlrev_b32 v22, 3, v12
    v_lshl_or_b32 v22, v13, 5, v22
    v_lshl_or_b32 v22, v15, 7, v22
    v_lshl_or_b32 v22, v10, 10, v22
    v_add_u32 v22, 80384, v22
    v_xor_b32 v23, v10, v11
    v_lshlrev_b32 v23, 4, v23
    v_lshl_add_u32 v23, v11, 8, v23
    v_add_u32 v23, 113152, v23
    s_lshl_b32 s53, s51, 10
    s_add_u32 s53, s53, 16842752
    v_lshl_add_u32 v14, v1, 4, s53
    s_mov_b32 s53, 3216550459
    s_waitcnt vmcnt(1)
    v_lshlrev_b32 v16, 16, v16
    v_mul_f32 v16, s53, v16
    v_lshlrev_b32 v17, 16, v17
    v_mul_f32 v17, s53, v17
    v_lshlrev_b32 v18, 16, v18
    v_mul_f32 v18, s53, v18
    v_lshlrev_b32 v19, 16, v19
    v_mul_f32 v19, s53, v19
    v_cvt_pk_bf16_f32 v20, v16, v17
    v_cvt_pk_bf16_f32 v21, v18, v19
    buffer_store_dwordx4 v[20:23], v14, s[44:47], 0 offen sc1
    s_branch K1_NOINFO
.globl agg_kernel
.p2align 8
.type agg_kernel,@function
agg_kernel:
    s_cmp_ge_u32 s2, 256
    s_cbranch_scc1 K2_END
    s_load_dwordx2 s[28:29], s[0:1], 88
    s_load_dwordx2 s[52:53], s[0:1], 0
    s_load_dwordx2 s[36:37], s[0:1], 32
    s_load_dwordx2 s[4:5], s[0:1], 56
    s_load_dwordx2 s[56:57], s[0:1], 72
    s_setprio 3
    v_lshrrev_b32 v2, 6, v0
    v_and_b32 v1, 63, v0
    v_readfirstlane_b32 s78, v2
    s_bfe_u32 s76, s2, 0x10002
    s_lshr_b32 s77, s2, 3
    s_and_b32 s3, s2, 3
    s_lshl_b32 s3, s3, 5
    s_add_u32 s77, s77, s3
    s_lshl_b32 s13, s77, 9
    s_add_u32 s13, s13, 16777216
    s_mul_i32 s77, s77, 25088
    s_mov_b32 s30, 41943040
    s_mov_b32 s31, 0x20000
    s_mov_b32 s3, 37536
    v_lshrrev_b32 v2, 3, v0
    v_and_b32 v15, 7, v0
    v_lshl_add_u32 v3, v2, 2, s13
    v_mul_u32_u24 v117, s3, v2
    v_mad_u32_u24 v117, v15, 12, v117
    v_add_u32 v117, 8388608, v117
    v_lshrrev_b32 v6, 4, v1
    v_and_b32 v7, 15, v1
    s_lshl_b32 s3, s76, 10
    s_add_u32 s3, s3, 16842752
    v_lshl_add_u32 v4, v1, 4, s3
    v_mov_b32 v118, 4
    v_mov_b32 v19, 0
    s_cmp_lt_u32 s78, 8
    s_cbranch_scc1 K2_GPRE
    s_cmp_lt_u32 s78, 13
    s_cbranch_scc1 K2_PRE_DONE
    v_subrev_u32 v76, 832, v0
    v_lshlrev_b32 v5, 4, v76
    v_subrev_u32 v77, 128, v76
    v_cmp_gt_u32 vcc, 16, v77
    v_mov_b32 v68, 1418082237
    v_add_u32 v78, 77584, v5
    v_cndmask_b32 v68, 0, v68, vcc
    v_cmp_lt_u32 vcc, 144, v76
    s_nop 1
    v_cndmask_b32 v68, v68, 1.0, vcc
    v_cndmask_b32 v5, v5, v78, vcc
    v_cmp_gt_u32 vcc, 161, v76
    v_mov_b32 v69, v68
    v_mov_b32 v70, v68
    v_mov_b32 v71, v68
    s_mov_b64 exec, vcc
    ds_write_b128 v5, v[68:71]
    s_mov_b64 exec, -1
K2_PRE_DONE:
    s_waitcnt lgkmcnt(0)
    buffer_load_dword v116, v3, s[28:31], 0 offen
    buffer_load_dwordx4 v[24:27], v4, s[28:31], 0 offen
    s_barrier
    s_waitcnt vmcnt(0)
    s_branch K2_INFO
K2_GPRE:
    v_xor_b32 v16, v6, v7
    v_lshlrev_b32 v16, 4, v16
    v_lshl_add_u32 v32, v6, 8, v16
    s_lshl_b32 s3, s78, 12
    s_add_u32 s83, s3, s77
    v_add_u32 v32, s83, v32
    s_add_u32 s83, s77, 25088
    s_min_u32 s54, s83, 3200000
    s_mov_b32 s55, 0x20000
    v_xor_b32 v33, 64, v32
    v_xor_b32 v34, 128, v32
    v_xor_b32 v35, 192, v32
    v_lshrrev_b32 v37, 3, v1
    v_lshlrev_b32 v37, 8, v37
    v_bfe_u32 v36, v1, 4, 1
    v_lshlrev_b32 v36, 1, v36
    v_and_b32 v38, 7, v1
    v_xor_b32 v36, v36, v38
    v_lshl_add_u32 v36, v36, 4, v37
    v_xor_b32 v37, 64, v36
    s_mov_b32 s38, 32768
    s_mov_b32 s39, 0x20000
    s_add_u32 s80, s3, 113152
    s_mov_b32 m0, s80
    s_add_u32 s79, s3, 80384
    s_and_b32 s3, s78, 3
    s_lshl_b32 s3, s3, 13
    s_lshl_b32 s83, s76, 7
    s_add_u32 s24, s3, s83
    s_add_u32 s25, s24, 1024
    s_add_u32 s26, s24, 2048
    s_add_u32 s27, s24, 3072
    s_waitcnt lgkmcnt(0)
    buffer_load_dword v116, v3, s[28:31], 0 offen
    buffer_load_dwordx4 v[24:27], v4, s[28:31], 0 offen
    s_barrier
    s_cmp_lt_u32 s78, 4
    buffer_load_dwordx4 v32, s[52:55], 0 offen offset:0 lds
    buffer_load_dwordx4 v33, s[52:55], 0 offen offset:1024 lds
    buffer_load_dwordx4 v34, s[52:55], 0 offen offset:2048 lds
    buffer_load_dwordx4 v35, s[52:55], 0 offen offset:3072 lds
    s_mov_b32 m0, s79
    s_cselect_b64 s[36:37], s[36:37], s[4:5]
    buffer_load_dwordx4 v36, s[36:39], s24 offen offset:0 lds
    buffer_load_dwordx4 v37, s[36:39], s25 offen offset:1024 lds
    buffer_load_dwordx4 v36, s[36:39], s26 offen offset:2048 lds
    buffer_load_dwordx4 v37, s[36:39], s27 offen offset:3072 lds
    s_waitcnt vmcnt(8)
K2_INFO:
    s_mul_i32 s83, s76, 3211264
    v_and_b32 v3, 0xffff, v116
    v_lshrrev_b32 v116, 16, v116
    v_add_u32 v117, v3, v117
    v_sub_u32 v116, v116, v15
    v_cmp_lt_i32 s[60:61], 0, v116
    v_cmp_lt_i32 s[62:63], 8, v116
    v_cmp_lt_i32 s[64:65], 16, v116
    v_cmp_lt_i32 s[66:67], 24, v116
    v_cmp_lt_i32 s[68:69], 32, v116
    v_cmp_lt_i32 s[70:71], 40, v116
    v_cmp_lt_i32 s[72:73], 48, v116
    s_add_u32 s40, s28, s83
    s_addc_u32 s41, s29, 0
    s_mov_b32 s43, 0x20000
    s_cmp_lt_u32 s78, 8
    s_cbranch_scc0 K2_NOSIG
    s_waitcnt vmcnt(0)
    s_mov_b64 exec, 1
    ds_add_u32 v19, v118 offset:2308
K2_NOSIG:
    s_cmp_lt_u32 s78, 4
    s_cbranch_scc1 K2_RI
    s_mov_b64 exec, s[60:61]
    buffer_load_dwordx3 v[64:66], v117, s[28:31], 0 offen offset:0
    s_mov_b64 exec, s[62:63]
    buffer_load_dwordx3 v[68:70], v117, s[28:31], 0 offen offset:96
    s_mov_b64 exec, s[64:65]
    buffer_load_dwordx3 v[72:74], v117, s[28:31], 0 offen offset:192
    s_mov_b64 exec, s[66:67]
    s_cbranch_execz K2_RI
    buffer_load_dwordx3 v[76:78], v117, s[28:31], 0 offen offset:288
    s_mov_b64 exec, s[68:69]
    s_cbranch_execz K2_RI
    buffer_load_dwordx3 v[80:82], v117, s[28:31], 0 offen offset:384
    s_mov_b64 exec, s[70:71]
    s_cbranch_execz K2_RI
    buffer_load_dwordx3 v[84:86], v117, s[28:31], 0 offen offset:480
    s_mov_b64 exec, s[72:73]
    s_cbranch_execz K2_RI
    buffer_load_dwordx3 v[88:90], v117, s[28:31], 0 offen offset:576
K2_RI:
    s_mov_b64 exec, -1
    s_setprio 0
    s_lshr_b32 s3, s2, 3
    s_mul_i32 s3, s3, 782
    s_mov_b32 s83, 512
    s_cmp_lt_u32 s78, 8
    s_cselect_b32 s83, s83, 896
    s_sub_u32 s3, s3, s83
    v_add_lshl_u32 v23, v0, s3, 7
    s_mov_b32 s42, 3200256
    s_sub_u32 s79, s78, 8
    s_cmp_lt_u32 s79, 0
    s_cbranch_scc0 K2_NOT1
    buffer_load_dword v23, v23, s[40:43], 0 offen
K2_NOT1:
    v_cmp_lt_i32 vcc, 56, v116
    s_mov_b32 s74, 0
    s_mov_b32 s81, 0
    s_mov_b32 s75, 784
    s_mov_b32 s12, 0xffffff00
    s_mov_b64 exec, vcc
    ds_write_b32 v19, v118 offset:2312
    s_mov_b64 exec, -1
    s_mov_b32 s16, 3216550459
    s_mov_b32 s17, 3216550459
    s_mov_b32 s18, 0x07060100
    s_mov_b32 s19, 0x07060302
    s_mov_b64 s[14:15], 0
    v_lshl_add_u32 v8, s76, 3, v15
    v_lshlrev_b32 v18, 8, v2
    v_lshl_add_u32 v12, v8, 4, v18
    v_and_b32 v3, 15, v2
    v_xor_b32 v8, v8, v3
    v_lshl_add_u32 v8, v8, 4, v18
    v_add_u32 v8, 113152, v8
    v_lshlrev_b32 v13, 3, v1
    v_lshlrev_b32 v22, 4, v7
    s_lshr_b32 s3, s78, 1
    s_lshl_b32 s83, s3, 12
    v_add_u32 v124, s83, v27
    v_xor_b32 v125, 64, v124
    v_xor_b32 v126, 128, v124
    v_xor_b32 v127, 192, v124
    s_and_b32 s83, s78, 1
    s_lshl_b32 s83, s83, 6
    v_bfe_u32 v3, v1, 2, 2
    v_xor_b32 v16, s83, v26
    v_xor_b32 v17, 32, v16
    v_lshl_add_u32 v2, s3, 4, v7
    v_cmp_gt_u32 vcc, 98, v2
    s_lshl_b32 s83, s83, 1
    v_mad_u32_u24 v14, v6, 16, s83
    s_mov_b64 s[10:11], vcc
    v_mad_u32_u24 v14, v2, s75, v14
    s_mov_b32 s20, 0x22221111
    s_mov_b32 s21, 0x88884444
    s_lshl_b32 s3, s78, 2
    v_add_u32 v119, s3, v6
    v_add_u32 v20, s3, v3
K2_POLL:
    ds_read_b32 v18, v19 offset:2308
    s_waitcnt lgkmcnt(0)
    v_readfirstlane_b32 s3, v18
    s_cmp_lt_u32 s3, 32
    s_cbranch_scc1 K2_POLL
    ds_read_b128 v[8:11], v8
    s_cmp_ge_u32 s78, 14
    s_cbranch_scc1 K2_NOGEMM
    ds_read_b128 v[32:35], v124
    ds_read_b128 v[36:39], v125
    ds_read_b128 v[40:43], v126
    ds_read_b128 v[44:47], v127
    ds_read_b64_tr_b16 v[48:49], v16 offset:0
    ds_read_b64_tr_b16 v[50:51], v16 offset:512
    ds_read_b64_tr_b16 v[52:53], v17 offset:0
    ds_read_b64_tr_b16 v[54:55], v17 offset:512
    v_mov_b32 v4, 3262644224
    v_mov_b32 v5, 3262644224
    s_mov_b32 s3, 1109809910
    ds_read_b64_tr_b16 v[56:57], v16 offset:16384
    ds_read_b64_tr_b16 v[58:59], v16 offset:16896
    ds_read_b64_tr_b16 v[60:61], v17 offset:16384
    ds_read_b64_tr_b16 v[62:63], v17 offset:16896
    s_waitcnt lgkmcnt(4)
    v_mfma_f32_16x16x32_bf16 v[100:103], v[48:51], v[32:35], 0
    v_mfma_f32_16x16x32_bf16 v[104:107], v[52:55], v[32:35], 0
    ds_read_b64_tr_b16 v[48:49], v16 offset:4096
    ds_read_b64_tr_b16 v[50:51], v16 offset:4608
    ds_read_b64_tr_b16 v[52:53], v17 offset:4096
    ds_read_b64_tr_b16 v[54:55], v17 offset:4608
    s_waitcnt lgkmcnt(4)
    v_mfma_f32_16x16x32_bf16 v[108:111], v[56:59], v[32:35], 0
    v_mfma_f32_16x16x32_bf16 v[112:115], v[60:63], v[32:35], 0
    ds_read_b64_tr_b16 v[56:57], v16 offset:20480
    ds_read_b64_tr_b16 v[58:59], v16 offset:20992
    ds_read_b64_tr_b16 v[60:61], v17 offset:20480
    ds_read_b64_tr_b16 v[62:63], v17 offset:20992
    s_waitcnt lgkmcnt(4)
    v_mfma_f32_16x16x32_bf16 v[100:103], v[48:51], v[36:39], v[100:103]
    v_mfma_f32_16x16x32_bf16 v[104:107], v[52:55], v[36:39], v[104:107]
    ds_read_b64_tr_b16 v[48:49], v16 offset:8192
    ds_read_b64_tr_b16 v[50:51], v16 offset:8704
    ds_read_b64_tr_b16 v[52:53], v17 offset:8192
    ds_read_b64_tr_b16 v[54:55], v17 offset:8704
    s_waitcnt lgkmcnt(4)
    v_mfma_f32_16x16x32_bf16 v[108:111], v[56:59], v[36:39], v[108:111]
    v_mfma_f32_16x16x32_bf16 v[112:115], v[60:63], v[36:39], v[112:115]
    ds_read_b64_tr_b16 v[56:57], v16 offset:24576
    ds_read_b64_tr_b16 v[58:59], v16 offset:25088
    ds_read_b64_tr_b16 v[60:61], v17 offset:24576
    ds_read_b64_tr_b16 v[62:63], v17 offset:25088
    s_waitcnt lgkmcnt(4)
    v_mfma_f32_16x16x32_bf16 v[100:103], v[48:51], v[40:43], v[100:103]
    v_mfma_f32_16x16x32_bf16 v[104:107], v[52:55], v[40:43], v[104:107]
    ds_read_b64_tr_b16 v[48:49], v16 offset:12288
    ds_read_b64_tr_b16 v[50:51], v16 offset:12800
    ds_read_b64_tr_b16 v[52:53], v17 offset:12288
    ds_read_b64_tr_b16 v[54:55], v17 offset:12800
    s_waitcnt lgkmcnt(4)
    v_mfma_f32_16x16x32_bf16 v[108:111], v[56:59], v[40:43], v[108:111]
    v_mfma_f32_16x16x32_bf16 v[112:115], v[60:63], v[40:43], v[112:115]
    ds_read_b64_tr_b16 v[56:57], v16 offset:28672
    ds_read_b64_tr_b16 v[58:59], v16 offset:29184
    ds_read_b64_tr_b16 v[60:61], v17 offset:28672
    ds_read_b64_tr_b16 v[62:63], v17 offset:29184
    s_waitcnt lgkmcnt(4)
    v_mfma_f32_16x16x32_bf16 v[100:103], v[48:51], v[44:47], v[100:103]
    v_mfma_f32_16x16x32_bf16 v[104:107], v[52:55], v[44:47], v[104:107]
    s_waitcnt lgkmcnt(0)
    v_mfma_f32_16x16x32_bf16 v[108:111], v[56:59], v[44:47], v[108:111]
    v_mfma_f32_16x16x32_bf16 v[112:115], v[60:63], v[44:47], v[112:115]
    s_nop 3
    v_max3_f32 v2, |v100|, |v101|, |v102|
    v_max3_f32 v3, |v103|, |v104|, |v105|
    v_max3_f32 v2, v2, |v106|, |v107|
    v_max_f32 v2, v2, v3
    v_cmp_lt_f32 vcc, s3, v2
    v_pk_fma_f32 v[32:33], v[100:101], s[16:17], v[4:5]
    v_pk_fma_f32 v[34:35], v[102:103], s[16:17], v[4:5]
    v_pk_fma_f32 v[36:37], v[104:105], s[16:17], v[4:5]
    v_pk_fma_f32 v[38:39], v[106:107], s[16:17], v[4:5]
    s_and_b64 s[14:15], vcc, s[10:11]
    v_exp_f32 v32, v32
    v_exp_f32 v33, v33
    v_exp_f32 v34, v34
    v_exp_f32 v35, v35
    v_exp_f32 v36, v36
    v_exp_f32 v37, v37
    v_exp_f32 v38, v38
    v_exp_f32 v39, v39
    v_cvt_pk_bf16_f32 v108, v108, v109
    v_cvt_pk_bf16_f32 v110, v110, v111
    v_cvt_pk_bf16_f32 v112, v112, v113
    v_cvt_pk_bf16_f32 v114, v114, v115
    v_perm_b32 v48, v32, v108, s18
    v_perm_b32 v49, v33, v108, s19
    v_perm_b32 v50, v34, v110, s18
    v_perm_b32 v51, v35, v110, s19
    v_perm_b32 v52, v36, v112, s18
    v_perm_b32 v53, v37, v112, s19
    v_perm_b32 v54, v38, v114, s18
    v_perm_b32 v55, v39, v114, s19
    s_mov_b64 exec, s[10:11]
    ds_write_b128 v14, v[48:51] offset:3072
    ds_write_b128 v14, v[52:55] offset:3136
    s_mov_b64 exec, s[14:15]
    ds_write_b32 v19, v118 offset:2304
K2_NOGEMM:
    s_cmp_lt_u32 s78, 4
    s_cbranch_scc0 K2_RI2
    s_mov_b64 exec, s[60:61]
    buffer_load_dwordx3 v[64:66], v117, s[28:31], 0 offen offset:0
    s_mov_b64 exec, s[62:63]
    buffer_load_dwordx3 v[68:70], v117, s[28:31], 0 offen offset:96
    s_mov_b64 exec, s[64:65]
    buffer_load_dwordx3 v[72:74], v117, s[28:31], 0 offen offset:192
    s_mov_b64 exec, s[66:67]
    s_cbranch_execz K2_RI2
    buffer_load_dwordx3 v[76:78], v117, s[28:31], 0 offen offset:288
    s_mov_b64 exec, s[68:69]
    s_cbranch_execz K2_RI2
    buffer_load_dwordx3 v[80:82], v117, s[28:31], 0 offen offset:384
    s_mov_b64 exec, s[70:71]
    s_cbranch_execz K2_RI2
    buffer_load_dwordx3 v[84:86], v117, s[28:31], 0 offen offset:480
    s_mov_b64 exec, s[72:73]
    s_cbranch_execz K2_RI2
    buffer_load_dwordx3 v[88:90], v117, s[28:31], 0 offen offset:576
K2_RI2:
    s_mov_b64 exec, -1
    s_cmp_lt_u32 s79, 0
    s_cbranch_scc1 K2_W1
    s_waitcnt vmcnt(0)
K2_W1:
    s_waitcnt vmcnt(1)
K2_BATCH:
    s_mov_b64 exec, s[60:61]
    v_lshlrev_b32_sdwa v92, 2, v66 dst_sel:DWORD dst_unused:UNUSED_PAD src0_sel:DWORD src1_sel:BYTE_0
    ds_add_rtn_u32 v67, v92, v118
    s_mov_b64 exec, s[62:63]
    v_lshlrev_b32_sdwa v93, 2, v70 dst_sel:DWORD dst_unused:UNUSED_PAD src0_sel:DWORD src1_sel:BYTE_0
    ds_add_rtn_u32 v71, v93, v118
    s_mov_b64 exec, s[64:65]
    v_lshlrev_b32_sdwa v94, 2, v74 dst_sel:DWORD dst_unused:UNUSED_PAD src0_sel:DWORD src1_sel:BYTE_0
    ds_add_rtn_u32 v75, v94, v118
    s_mov_b64 exec, s[66:67]
    s_cbranch_execz K2_AT_DONE
    v_lshlrev_b32_sdwa v95, 2, v78 dst_sel:DWORD dst_unused:UNUSED_PAD src0_sel:DWORD src1_sel:BYTE_0
    ds_add_rtn_u32 v79, v95, v118
    s_mov_b64 exec, s[68:69]
    s_cbranch_execz K2_AT_DONE
    v_lshlrev_b32_sdwa v96, 2, v82 dst_sel:DWORD dst_unused:UNUSED_PAD src0_sel:DWORD src1_sel:BYTE_0
    ds_add_rtn_u32 v83, v96, v118
    s_mov_b64 exec, s[70:71]
    s_cbranch_execz K2_AT_DONE
    v_lshlrev_b32_sdwa v97, 2, v86 dst_sel:DWORD dst_unused:UNUSED_PAD src0_sel:DWORD src1_sel:BYTE_0
    ds_add_rtn_u32 v87, v97, v118
    s_mov_b64 exec, s[72:73]
    s_cbranch_execz K2_AT_DONE
    v_lshlrev_b32_sdwa v98, 2, v90 dst_sel:DWORD dst_unused:UNUSED_PAD src0_sel:DWORD src1_sel:BYTE_0
    ds_add_rtn_u32 v91, v98, v118
K2_AT_DONE:
    s_mov_b64 exec, -1
    s_waitcnt lgkmcnt(0)
    s_barrier
    ds_read_b64 v[2:3], v13
    ds_read_b96 v[16:18], v19 offset:2304
    s_cmp_ge_u32 s78, 14
    s_cbranch_scc0 K2_NOTOUCH
    buffer_load_dword v23, v23, s[40:43], 0 offen
K2_NOTOUCH:
    s_waitcnt lgkmcnt(0)
    v_add_u32 v4, 4, v2
    v_add_u32 v5, 4, v3
    v_and_b32 v4, -8, v4
    v_and_b32 v5, -8, v5
    v_add_u32 v59, v4, v5
    v_add_u32 v58, v4, v5
    v_readfirstlane_b32 s82, v16
    v_readfirstlane_b32 s80, v18
    v_add_u32_dpp v58, v58, v58 row_shr:1 row_mask:0xf bank_mask:0xf bound_ctrl:1
    s_nop 1
    v_add_u32_dpp v58, v58, v58 row_shr:2 row_mask:0xf bank_mask:0xf bound_ctrl:1
    s_nop 1
    v_add_u32_dpp v58, v58, v58 row_shr:4 row_mask:0xf bank_mask:0xf bound_ctrl:1
    s_nop 1
    v_add_u32_dpp v58, v58, v58 row_shr:8 row_mask:0xf bank_mask:0xf bound_ctrl:1
    s_nop 1
    v_add_u32_dpp v58, v58, v58 row_bcast:15 row_mask:0xa bank_mask:0xf
    s_nop 1
    v_add_u32_dpp v58, v58, v58 row_bcast:31 row_mask:0xc bank_mask:0xf
    v_sub_u32 v56, v58, v59
    v_readlane_b32 s83, v58, 63
    v_add_u32 v56, 142848, v56
    v_add_u32 v57, v56, v4
    ds_write_b64 v13, v[56:57] offset:512
    s_cmp_gt_u32 s83, 14336
    s_cselect_b32 s80, 1, s80
    s_cmp_lg_u32 s80, 0
    s_cbranch_scc1 K2_SLOWINIT
K2_DECIDED:
    s_add_u32 s79, s83, 511
    s_lshr_b32 s79, s79, 9
    s_mov_b64 exec, s[60:61]
    ds_read_b32 v92, v92 offset:512
    s_mov_b64 exec, s[62:63]
    ds_read_b32 v93, v93 offset:512
    s_mov_b64 exec, s[64:65]
    ds_read_b32 v94, v94 offset:512
    s_mov_b64 exec, s[66:67]
    s_cbranch_execz K2_RD_DONE
    ds_read_b32 v95, v95 offset:512
    s_mov_b64 exec, s[68:69]
    s_cbranch_execz K2_RD_DONE
    ds_read_b32 v96, v96 offset:512
    s_mov_b64 exec, s[70:71]
    s_cbranch_execz K2_RD_DONE
    ds_read_b32 v97, v97 offset:512
    s_mov_b64 exec, s[72:73]
    s_cbranch_execz K2_RD_DONE
    ds_read_b32 v98, v98 offset:512
K2_RD_DONE:
    s_mov_b64 exec, -1
    s_lshl_b32 s3, s79, 3
    v_lshl_add_u32 v118, v119, 9, v22
    v_mul_u32_u24 v119, s3, v119
    s_lshl_b32 s3, s3, 1
    v_mul_u32_u24 v20, s3, v20
    v_add_u32 v119, 142848, v119
    v_add_u32 v20, 111616, v20
    v_add_u32 v118, 77824, v118
    v_cndmask_b32 v20, 0, v20, s[20:21]
    v_lshl_add_u32 v62, v7, 3, v119
    s_mov_b32 s8, 4294794752
    s_cmp_gt_u32 s78, 3
    s_cbranch_scc1 K2_NOAUX
    v_mov_b32 v124, 0
    v_mov_b32 v125, 0
    v_mov_b32 v122, 3200098
    s_cmp_lt_u32 s78, 2
    s_cbranch_scc1 K2_AUXPAD
    s_lshl_b32 s80, s78, 8
    s_add_u32 s80, s80, s83
    s_add_u32 s80, s80, 142336
    v_lshl_add_u32 v123, v1, 2, s80
    s_branch K2_AUXW
K2_AUXPAD:
    s_cmp_eq_u32 s78, 0
    s_cselect_b64 vcc, -1, 0
    v_cndmask_b32 v126, v3, v2, vcc
    v_cndmask_b32 v123, v57, v56, vcc
    v_add_u32 v123, v123, v126
    v_and_b32 v126, 4, v126
    v_cmp_ne_u32 vcc, 0, v126
    s_mov_b64 exec, vcc
K2_AUXW:
    ds_write_b32 v123, v122
    v_lshl_add_u32 v123, v123, 1, s8
    ds_write_b64 v123, v[124:125]
K2_NOAUX:
    s_waitcnt lgkmcnt(0)
    s_mov_b64 exec, s[60:61]
    v_add_u32 v92, v92, v67
    ds_write_b32 v92, v66
    s_mov_b64 exec, s[62:63]
    v_add_u32 v93, v93, v71
    ds_write_b32 v93, v70
    s_mov_b64 exec, s[64:65]
    v_add_u32 v94, v94, v75
    ds_write_b32 v94, v74
    s_mov_b64 exec, s[66:67]
    s_cbranch_execz K2_SC_DONE
    v_add_u32 v95, v95, v79
    ds_write_b32 v95, v78
    s_mov_b64 exec, s[68:69]
    s_cbranch_execz K2_SC_DONE
    v_add_u32 v96, v96, v83
    ds_write_b32 v96, v82
    s_mov_b64 exec, s[70:71]
    s_cbranch_execz K2_SC_DONE
    v_add_u32 v97, v97, v87
    ds_write_b32 v97, v86
    s_mov_b64 exec, s[72:73]
    s_cbranch_execz K2_SC_DONE
    v_add_u32 v98, v98, v91
    ds_write_b32 v98, v90
K2_SC_DONE:
    s_mov_b64 exec, -1
    s_cmp_eq_u32 s82, 4
    s_cbranch_scc1 K2_RMFIX
K2_NORM:
    s_waitcnt lgkmcnt(0)
    s_barrier
    ds_read_b64 v[40:41], v119
    ds_read_b64 v[110:111], v119 offset:8
    ds_read_b64 v[112:113], v119 offset:16
    ds_read_b64 v[114:115], v119 offset:24
    ds_read2_b32 v[60:61], v62 offset0:0 offset1:2
    ds_read2_b32 v[62:63], v62 offset0:32 offset1:34
    ds_read_b64 v[108:109], v119 offset:32
    v_lshrrev_b32 v19, 3, v0
    v_and_b32 v14, 7, v0
    v_lshlrev_b32 v14, 5, v14
    v_lshlrev_b32 v42, 2, v19
    v_mad_u32_u24 v19, v19, s75, v14
    s_waitcnt lgkmcnt(6)
    v_and_or_b32 v116, v40, s12, v22
    v_and_or_b32 v117, v41, s12, v22
    buffer_load_dwordx4 v[32:35], v116, s[40:43], 0 offen
    buffer_load_dwordx4 v[36:39], v117, s[40:43], 0 offen
    v_and_b32 v41, 0x7f, v40
    v_mad_u32_u24 v41, v41, s75, v22
    ds_read_b128 v[100:103], v41 offset:3072
    ds_read_b128 v[120:123], v19 offset:3072
    ds_read_b128 v[124:127], v19 offset:3088
    s_cmp_lt_u32 s78, 4
    s_cbranch_scc1 K2_SE
    s_setprio 1
    s_cmp_lg_u32 s74, 0
    s_cbranch_scc1 K2_NOLATEA
    v_add_u32 v12, s77, v12
    v_mov_b32 v26, 545259520
    v_mov_b32 v27, 545259520
    v_mov_b32 v46, 0x3f80
    s_mov_b32 s4, 0x00100001
    s_mov_b32 s5, 0x10000100
    s_lshl_b64 s[6:7], s[4:5], 1
    s_lshl_b64 s[10:11], s[4:5], 2
    s_lshl_b64 vcc, s[4:5], 3
    v_cndmask_b32 v28, 0, v46, s[4:5]
    v_cndmask_b32 v29, 0, v46, s[6:7]
    v_cndmask_b32 v30, 0, v46, s[10:11]
    v_cndmask_b32 v31, 0, v46, vcc
    v_cndmask_b32 v21, 0, 64, s[20:21]
K2_NOLATEA:
    v_lshlrev_b32 v2, 16, v8
    v_and_b32 v3, 0xffff0000, v8
    v_lshlrev_b32 v4, 16, v9
    v_and_b32 v5, 0xffff0000, v9
    v_lshlrev_b32 v15, 16, v10
    v_and_b32 v16, 0xffff0000, v10
    v_lshlrev_b32 v17, 16, v11
    v_and_b32 v18, 0xffff0000, v11
    v_add_u32 v6, 1536, v14
    s_waitcnt lgkmcnt(0)
    v_xor_b32 v60, v60, v61
    v_xor_b32 v62, v62, v63
    v_and_b32 v60, 0x7f, v60
    v_and_b32 v62, 0x7f, v62
    v_cmp_ne_u32 s[4:5], 0, v60
    v_cmp_ne_u32 s[6:7], 0, v62
    s_movk_i32 s3, 0x3f80
    v_dot2_f32_bf16 v120, v120, s3, v2
    v_dot2_f32_bf16 v121, v121, s3, v3
    v_dot2_f32_bf16 v122, v122, s3, v4
    v_dot2_f32_bf16 v123, v123, s3, v5
    v_dot2_f32_bf16 v124, v124, s3, v15
    v_dot2_f32_bf16 v125, v125, s3, v16
    v_dot2_f32_bf16 v126, v126, s3, v17
    v_dot2_f32_bf16 v127, v127, s3, v18
K2_SE:
    s_mov_b64 exec, s[60:61]
    v_lshl_add_u32 v92, v92, 1, s8
    ds_write_b64 v92, v[64:65]
    s_mov_b64 exec, s[62:63]
    v_lshl_add_u32 v93, v93, 1, s8
    ds_write_b64 v93, v[68:69]
    s_mov_b64 exec, s[64:65]
    v_lshl_add_u32 v94, v94, 1, s8
    ds_write_b64 v94, v[72:73]
    s_mov_b64 exec, s[66:67]
    s_cbranch_execz K2_SE_DONE
    v_lshl_add_u32 v95, v95, 1, s8
    ds_write_b64 v95, v[76:77]
    s_mov_b64 exec, s[68:69]
    s_cbranch_execz K2_SE_DONE
    v_lshl_add_u32 v96, v96, 1, s8
    ds_write_b64 v96, v[80:81]
    s_mov_b64 exec, s[70:71]
    s_cbranch_execz K2_SE_DONE
    v_lshl_add_u32 v97, v97, 1, s8
    ds_write_b64 v97, v[84:85]
    s_mov_b64 exec, s[72:73]
    s_cbranch_execz K2_SE_DONE
    v_lshl_add_u32 v98, v98, 1, s8
    ds_write_b64 v98, v[88:89]
K2_SE_DONE:
    s_mov_b64 exec, -1
    s_cmp_lt_u32 s78, 4
    s_cbranch_scc0 K2_NODESC
    s_cmp_lg_u32 s78, 0
    s_cbranch_scc1 K2_OLDSIDE
    s_max_u32 s80, s79, 1
    v_cvt_f32_u32 v44, s80
    v_rcp_f32 v44, v44
    v_subrev_u32 v56, 142848, v56
    v_subrev_u32 v57, 142848, v57
    v_mul_f32 v44, 1233125376, v44
    v_lshrrev_b32 v56, 3, v56
    v_lshrrev_b32 v57, 3, v57
    v_cvt_u32_f32 v44, v44
    v_lshrrev_b32 v58, 3, v58
    v_add_u32 v44, 2, v44
    s_sub_u32 s80, s80, 1
    v_add_u32 v48, s80, v56
    v_mul_lo_u32 v48, v48, v44
    v_lshrrev_b32 v48, 20, v48
    v_add_u32 v49, s80, v57
    v_mul_lo_u32 v49, v49, v44
    v_lshrrev_b32 v49, 20, v49
    v_add_u32 v50, s80, v58
    v_mul_lo_u32 v50, v50, v44
    v_lshrrev_b32 v50, 20, v50
    v_lshlrev_b32 v45, 1, v1
    v_mul_u32_u24 v45, s75, v45
    v_add_u32 v45, 2560, v45
    v_mov_b32 v44, 1792
    v_mul_u32_u24 v46, s79, v48
    v_cmp_ne_u32 vcc, v46, v56
    v_cmp_ne_u32 s[10:11], v56, v57
    s_and_b64 vcc, vcc, s[10:11]
    v_sub_u32 v47, v49, v48
    v_cndmask_b32 v46, v44, v45, vcc
    v_lshl_or_b32 v46, v48, 18, v46
    v_lshl_or_b32 v52, v47, 25, v46
    v_add_u32 v45, 784, v45
    v_mul_u32_u24 v46, s79, v49
    v_cmp_ne_u32 vcc, v46, v57
    v_cmp_ne_u32 s[10:11], v57, v58
    s_and_b64 vcc, vcc, s[10:11]
    v_sub_u32 v47, v50, v49
    v_cndmask_b32 v46, v44, v45, vcc
    v_lshl_or_b32 v46, v49, 18, v46
    v_lshl_or_b32 v53, v47, 25, v46
    v_add_u32 v45, 784, v45
    ds_write_b64 v13, v[52:53] offset:1024
K2_OLDSIDE:
    s_cmp_lg_u32 s74, 0
    s_cbranch_scc1 K2_NOLATEB
    v_add_u32 v12, s77, v12
    v_mov_b32 v26, 545259520
    v_mov_b32 v27, 545259520
    v_mov_b32 v46, 0x3f80
    s_mov_b32 s4, 0x00100001
    s_mov_b32 s5, 0x10000100
    s_lshl_b64 s[6:7], s[4:5], 1
    s_lshl_b64 s[10:11], s[4:5], 2
    s_lshl_b64 vcc, s[4:5], 3
    v_cndmask_b32 v28, 0, v46, s[4:5]
    v_cndmask_b32 v29, 0, v46, s[6:7]
    v_cndmask_b32 v30, 0, v46, s[10:11]
    v_cndmask_b32 v31, 0, v46, vcc
    v_cndmask_b32 v21, 0, 64, s[20:21]
K2_NOLATEB:
    v_lshlrev_b32 v2, 16, v8
    v_and_b32 v3, 0xffff0000, v8
    v_lshlrev_b32 v4, 16, v9
    v_and_b32 v5, 0xffff0000, v9
    v_lshlrev_b32 v15, 16, v10
    v_and_b32 v16, 0xffff0000, v10
    v_lshlrev_b32 v17, 16, v11
    v_and_b32 v18, 0xffff0000, v11
    v_add_u32 v6, 1536, v14
    s_waitcnt lgkmcnt(3)
    v_xor_b32 v60, v60, v61
    v_xor_b32 v62, v62, v63
    v_and_b32 v60, 0x7f, v60
    v_and_b32 v62, 0x7f, v62
    v_cmp_ne_u32 s[4:5], 0, v60
    v_cmp_ne_u32 s[6:7], 0, v62
    s_movk_i32 s3, 0x3f80
    v_dot2_f32_bf16 v120, v120, s3, v2
    v_dot2_f32_bf16 v121, v121, s3, v3
    v_dot2_f32_bf16 v122, v122, s3, v4
    v_dot2_f32_bf16 v123, v123, s3, v5
    v_dot2_f32_bf16 v124, v124, s3, v15
    v_dot2_f32_bf16 v125, v125, s3, v16
    v_dot2_f32_bf16 v126, v126, s3, v17
    v_dot2_f32_bf16 v127, v127, s3, v18
K2_NODESC:
    s_mov_b32 s58, 3200000
    s_mov_b32 s59, 0x20000
    s_mov_b32 s8, 0x00010001
    s_mov_b32 s9, 0x00010001
    s_sub_u32 s80, s79, 1
    s_and_b32 s83, s80, 15
    s_lshl_b64 s[10:11], s[8:9], s83
    s_cmp_lt_u32 s80, 16
    s_cselect_b64 vcc, s[10:11], 0
    s_cselect_b64 s[10:11], 0, s[10:11]
    s_or_b64 s[4:5], s[4:5], vcc
    s_or_b64 s[6:7], s[6:7], s[10:11]
    s_waitcnt lgkmcnt(0)
    s_barrier
    ds_read_b128 v[104:107], v20 offset:1536
    ds_read_b32 v7, v42 offset:1024
    ds_read_b128 v[92:95], v22 offset:1536
    ds_read_b128 v[96:99], v22 offset:1536
    s_setprio 3
    v_and_or_b32 v116, v110, s12, v22
    v_and_or_b32 v117, v111, s12, v22
    buffer_load_dwordx4 v[40:43], v116, s[40:43], 0 offen
    buffer_load_dwordx4 v[44:47], v117, s[40:43], 0 offen
    v_and_or_b32 v116, v112, s12, v22
    v_and_or_b32 v117, v113, s12, v22
    buffer_load_dwordx4 v[48:51], v116, s[40:43], 0 offen
    buffer_load_dwordx4 v[52:55], v117, s[40:43], 0 offen
    v_and_or_b32 v116, v114, s12, v22
    v_and_or_b32 v117, v115, s12, v22
    buffer_load_dwordx4 v[56:59], v116, s[40:43], 0 offen
    buffer_load_dwordx4 v[60:63], v117, s[40:43], 0 offen
    s_waitcnt lgkmcnt(0)
    v_and_b32 v19, 0x3ffff, v7
    v_add_u32 v19, v19, v14
    v_bfe_u32 v80, v7, 18, 7
    v_lshl_add_u32 v14, v80, 9, v14
    v_lshrrev_b32 v7, 25, v7
    v_cmp_ne_u32 vcc, 0, v7
    v_add_u32 v14, 80384, v14
    s_cmp_eq_u32 s79, 0
    v_cndmask_b32 v6, v6, v14, vcc
    s_cbranch_scc1 K2_LOOP_DONE
    s_sub_u32 s83, s79, 17
    s_cmp_gt_u32 s80, 3
    s_cselect_b32 s42, 3200256, 0
    s_waitcnt vmcnt(6)
    v_mfma_f32_16x16x16_bf16 v[64:67], v[104:105], v[24:25], v[32:35]
    v_mfma_f32_16x16x16_bf16 v[68:71], v[106:107], v[24:25], v[36:39]
    s_cmp_lg_u32 s82, 0
    s_nop 0
    ds_read_b128 v[104:107], v20 offset:1552
    s_nop 3
    s_cbranch_scc1 K2_LOOP_1
.p2align 6
K2_LOOP_0:
    v_mfma_f32_16x16x32_bf16 v[72:75], v[28:31], v[32:35], 0
    v_exp_f32 v64, v64
    v_exp_f32 v65, v65
    v_mfma_f32_16x16x32_bf16 v[76:79], v[28:31], v[36:39], 0
    v_exp_f32 v66, v66
    v_exp_f32 v67, v67
    v_exp_f32 v68, v68
    v_exp_f32 v69, v69
    v_exp_f32 v70, v70
    v_exp_f32 v71, v71
    s_waitcnt lgkmcnt(0)
    v_and_or_b32 v116, v108, s12, v22
    v_and_or_b32 v117, v109, s12, v22
    buffer_load_dwordx4 v[32:35], v116, s[40:43], 0 offen
    buffer_load_dwordx4 v[36:39], v117, s[40:43], 0 offen
    v_pk_fma_f32 v[64:65], v[64:65], v[100:101], v[26:27] clamp
    v_pk_fma_f32 v[66:67], v[66:67], v[102:103], v[26:27] clamp
    v_pk_fma_f32 v[68:69], v[68:69], v[100:101], v[26:27] clamp
    v_pk_fma_f32 v[70:71], v[70:71], v[102:103], v[26:27] clamp
    v_pk_mul_f32 v[80:81], v[64:65], v[68:69]
    v_pk_mul_f32 v[82:83], v[66:67], v[70:71]
    v_pk_add_f32 v[84:85], v[64:65], v[68:69]
    v_pk_add_f32 v[86:87], v[66:67], v[70:71]
    v_pk_mul_f32 v[88:89], v[72:73], v[68:69]
    v_pk_mul_f32 v[90:91], v[74:75], v[70:71]
    v_pk_fma_f32 v[88:89], v[76:77], v[64:65], v[88:89]
    v_pk_fma_f32 v[90:91], v[78:79], v[66:67], v[90:91]
    s_waitcnt vmcnt(6)
    v_mfma_f32_16x16x16_bf16 v[64:67], v[104:105], v[24:25], v[40:43]
    v_rcp_f32 v80, v80
    v_rcp_f32 v81, v81
    v_mfma_f32_16x16x16_bf16 v[68:71], v[106:107], v[24:25], v[44:47]
    v_rcp_f32 v82, v82
    v_rcp_f32 v83, v83
    s_and_b64 s[10:11], s[4:5], s[8:9]
    v_pk_fma_f32 v[96:97], v[84:85], v[80:81], v[96:97]
    v_pk_fma_f32 v[98:99], v[86:87], v[82:83], v[98:99]
    v_pk_fma_f32 v[92:93], v[88:89], v[80:81], v[92:93]
    v_pk_fma_f32 v[94:95], v[90:91], v[82:83], v[94:95]
    s_cbranch_scc1 K2_FL_0_0
K2_BK_0_0:
    ds_read_b64 v[110:111], v119 offset:40
    ds_read_b128 v[104:107], v20 offset:1568
    s_lshr_b64 s[4:5], s[4:5], 1
    s_sub_u32 s80, s80, 1
    s_cmp_gt_u32 s80, 3
    s_cselect_b32 s42, 3200256, 0
    v_mfma_f32_16x16x32_bf16 v[72:75], v[28:31], v[40:43], 0
    v_exp_f32 v64, v64
    v_exp_f32 v65, v65
    v_mfma_f32_16x16x32_bf16 v[76:79], v[28:31], v[44:47], 0
    v_exp_f32 v66, v66
    v_exp_f32 v67, v67
    v_exp_f32 v68, v68
    v_exp_f32 v69, v69
    v_exp_f32 v70, v70
    v_exp_f32 v71, v71
    s_waitcnt lgkmcnt(0)
    v_and_or_b32 v116, v110, s12, v22
    v_and_or_b32 v117, v111, s12, v22
    buffer_load_dwordx4 v[40:43], v116, s[40:43], 0 offen
    buffer_load_dwordx4 v[44:47], v117, s[40:43], 0 offen
    v_pk_fma_f32 v[64:65], v[64:65], v[100:101], v[26:27] clamp
    v_pk_fma_f32 v[66:67], v[66:67], v[102:103], v[26:27] clamp
    v_pk_fma_f32 v[68:69], v[68:69], v[100:101], v[26:27] clamp
    v_pk_fma_f32 v[70:71], v[70:71], v[102:103], v[26:27] clamp
    v_pk_mul_f32 v[80:81], v[64:65], v[68:69]
    v_pk_mul_f32 v[82:83], v[66:67], v[70:71]
    v_pk_add_f32 v[84:85], v[64:65], v[68:69]
    v_pk_add_f32 v[86:87], v[66:67], v[70:71]
    v_pk_mul_f32 v[88:89], v[72:73], v[68:69]
    v_pk_mul_f32 v[90:91], v[74:75], v[70:71]
    v_pk_fma_f32 v[88:89], v[76:77], v[64:65], v[88:89]
    v_pk_fma_f32 v[90:91], v[78:79], v[66:67], v[90:91]
    s_waitcnt vmcnt(6)
    v_mfma_f32_16x16x16_bf16 v[64:67], v[104:105], v[24:25], v[48:51]
    v_rcp_f32 v80, v80
    v_rcp_f32 v81, v81
    v_mfma_f32_16x16x16_bf16 v[68:71], v[106:107], v[24:25], v[52:55]
    v_rcp_f32 v82, v82
    v_rcp_f32 v83, v83
    s_and_b64 s[10:11], s[4:5], s[8:9]
    v_pk_fma_f32 v[96:97], v[84:85], v[80:81], v[96:97]
    v_pk_fma_f32 v[98:99], v[86:87], v[82:83], v[98:99]
    v_pk_fma_f32 v[92:93], v[88:89], v[80:81], v[92:93]
    v_pk_fma_f32 v[94:95], v[90:91], v[82:83], v[94:95]
    s_cbranch_scc1 K2_FL_0_1
K2_BK_0_1:
    ds_read_b64 v[112:113], v119 offset:48
    ds_read_b128 v[104:107], v20 offset:1584
    s_lshr_b64 s[4:5], s[4:5], 1
    s_sub_u32 s80, s80, 1
    s_cmp_gt_u32 s80, 3
    s_cselect_b32 s42, 3200256, 0
    v_mfma_f32_16x16x32_bf16 v[72:75], v[28:31], v[48:51], 0
    v_exp_f32 v64, v64
    v_exp_f32 v65, v65
    v_mfma_f32_16x16x32_bf16 v[76:79], v[28:31], v[52:55], 0
    v_exp_f32 v66, v66
    v_exp_f32 v67, v67
    v_exp_f32 v68, v68
    v_exp_f32 v69, v69
    v_exp_f32 v70, v70
    v_exp_f32 v71, v71
    s_waitcnt lgkmcnt(0)
    v_and_or_b32 v116, v112, s12, v22
    v_and_or_b32 v117, v113, s12, v22
    buffer_load_dwordx4 v[48:51], v116, s[40:43], 0 offen
    buffer_load_dwordx4 v[52:55], v117, s[40:43], 0 offen
    v_pk_fma_f32 v[64:65], v[64:65], v[100:101], v[26:27] clamp
    v_pk_fma_f32 v[66:67], v[66:67], v[102:103], v[26:27] clamp
    v_pk_fma_f32 v[68:69], v[68:69], v[100:101], v[26:27] clamp
    v_pk_fma_f32 v[70:71], v[70:71], v[102:103], v[26:27] clamp
    v_pk_mul_f32 v[80:81], v[64:65], v[68:69]
    v_pk_mul_f32 v[82:83], v[66:67], v[70:71]
    v_pk_add_f32 v[84:85], v[64:65], v[68:69]
    v_pk_add_f32 v[86:87], v[66:67], v[70:71]
    v_pk_mul_f32 v[88:89], v[72:73], v[68:69]
    v_pk_mul_f32 v[90:91], v[74:75], v[70:71]
    v_pk_fma_f32 v[88:89], v[76:77], v[64:65], v[88:89]
    v_pk_fma_f32 v[90:91], v[78:79], v[66:67], v[90:91]
    s_waitcnt vmcnt(6)
    v_mfma_f32_16x16x16_bf16 v[64:67], v[104:105], v[24:25], v[56:59]
    v_rcp_f32 v80, v80
    v_rcp_f32 v81, v81
    v_mfma_f32_16x16x16_bf16 v[68:71], v[106:107], v[24:25], v[60:63]
    v_rcp_f32 v82, v82
    v_rcp_f32 v83, v83
    s_and_b64 s[10:11], s[4:5], s[8:9]
    v_pk_fma_f32 v[96:97], v[84:85], v[80:81], v[96:97]
    v_pk_fma_f32 v[98:99], v[86:87], v[82:83], v[98:99]
    v_pk_fma_f32 v[92:93], v[88:89], v[80:81], v[92:93]
    v_pk_fma_f32 v[94:95], v[90:91], v[82:83], v[94:95]
    s_cbranch_scc1 K2_FL_0_2
K2_BK_0_2:
    ds_read_b64 v[114:115], v119 offset:56
    ds_read_b128 v[104:107], v20 offset:1600
    s_lshr_b64 s[4:5], s[4:5], 1
    s_sub_u32 s80, s80, 1
    s_cmp_gt_u32 s80, 3
    s_cselect_b32 s42, 3200256, 0
    v_mfma_f32_16x16x32_bf16 v[72:75], v[28:31], v[56:59], 0
    v_exp_f32 v64, v64
    v_exp_f32 v65, v65
    v_mfma_f32_16x16x32_bf16 v[76:79], v[28:31], v[60:63], 0
    v_exp_f32 v66, v66
    v_exp_f32 v67, v67
    v_exp_f32 v68, v68
    v_exp_f32 v69, v69
    v_exp_f32 v70, v70
    v_exp_f32 v71, v71
    s_waitcnt lgkmcnt(0)
    v_and_or_b32 v116, v114, s12, v22
    v_and_or_b32 v117, v115, s12, v22
    buffer_load_dwordx4 v[56:59], v116, s[40:43], 0 offen
    buffer_load_dwordx4 v[60:63], v117, s[40:43], 0 offen
    v_pk_fma_f32 v[64:65], v[64:65], v[100:101], v[26:27] clamp
    v_pk_fma_f32 v[66:67], v[66:67], v[102:103], v[26:27] clamp
    v_pk_fma_f32 v[68:69], v[68:69], v[100:101], v[26:27] clamp
    v_pk_fma_f32 v[70:71], v[70:71], v[102:103], v[26:27] clamp
    v_pk_mul_f32 v[80:81], v[64:65], v[68:69]
    v_pk_mul_f32 v[82:83], v[66:67], v[70:71]
    v_pk_add_f32 v[84:85], v[64:65], v[68:69]
    v_pk_add_f32 v[86:87], v[66:67], v[70:71]
    v_pk_mul_f32 v[88:89], v[72:73], v[68:69]
    v_pk_mul_f32 v[90:91], v[74:75], v[70:71]
    v_pk_fma_f32 v[88:89], v[76:77], v[64:65], v[88:89]
    v_pk_fma_f32 v[90:91], v[78:79], v[66:67], v[90:91]
    s_waitcnt vmcnt(6)
    v_mfma_f32_16x16x16_bf16 v[64:67], v[104:105], v[24:25], v[32:35]
    v_rcp_f32 v80, v80
    v_rcp_f32 v81, v81
    v_mfma_f32_16x16x16_bf16 v[68:71], v[106:107], v[24:25], v[36:39]
    v_rcp_f32 v82, v82
    v_rcp_f32 v83, v83
    s_and_b64 s[10:11], s[4:5], s[8:9]
    v_pk_fma_f32 v[96:97], v[84:85], v[80:81], v[96:97]
    v_pk_fma_f32 v[98:99], v[86:87], v[82:83], v[98:99]
    v_pk_fma_f32 v[92:93], v[88:89], v[80:81], v[92:93]
    v_pk_fma_f32 v[94:95], v[90:91], v[82:83], v[94:95]
    s_cbranch_scc1 K2_FL_0_3
K2_BK_0_3:
    ds_read_b64 v[108:109], v119 offset:64
    ds_read_b128 v[104:107], v20 offset:1616
    s_lshr_b64 s[4:5], s[4:5], 1
    s_sub_u32 s80, s80, 1
    s_cmp_gt_u32 s80, 3
    s_cselect_b32 s42, 3200256, 0
    v_add_u32 v119, 32, v119
    v_add_u32 v20, v21, v20
    s_cmp_eq_u32 s80, s83
    s_cselect_b64 s[4:5], s[6:7], s[4:5]
    s_cmp_ge_u32 s80, 16
    s_cbranch_scc1 K2_LOOP_0
    s_setprio 2
    s_cmp_ge_u32 s80, 8
    s_cbranch_scc1 K2_LOOP_0
    s_setprio 1
    s_cmp_ge_u32 s80, 4
    s_cbranch_scc1 K2_LOOP_0
    s_setprio 0
    s_branch K2_LOOP_0
K2_FL_0_0:
    s_mul_i32 exec_lo, s10, 0xffff
    s_mul_i32 exec_hi, s11, 0xffff
    ds_write_b128 v118, v[92:95] offset:2560
    ds_write_b128 v118, v[96:99] offset:2816
    v_and_b32 v116, 0x7f, v110
    v_mad_u32_u24 v118, v116, s75, v22
    s_cmp_lg_u32 s80, 0
    ds_read_b128 v[100:103], v118 offset:3072
    ds_read_b128 v[92:95], v22 offset:1536
    ds_read_b128 v[96:99], v22 offset:2048
    s_mov_b64 exec, -1
    s_cbranch_scc1 K2_BK_0_0
    s_branch K2_LOOP_DONE
K2_FL_0_1:
    s_mul_i32 exec_lo, s10, 0xffff
    s_mul_i32 exec_hi, s11, 0xffff
    ds_write_b128 v118, v[92:95] offset:2560
    ds_write_b128 v118, v[96:99] offset:2816
    v_and_b32 v116, 0x7f, v112
    v_mad_u32_u24 v118, v116, s75, v22
    s_cmp_lg_u32 s80, 0
    ds_read_b128 v[100:103], v118 offset:3072
    ds_read_b128 v[92:95], v22 offset:1536
    ds_read_b128 v[96:99], v22 offset:2048
    s_mov_b64 exec, -1
    s_cbranch_scc1 K2_BK_0_1
    s_branch K2_LOOP_DONE
K2_FL_0_2:
    s_mul_i32 exec_lo, s10, 0xffff
    s_mul_i32 exec_hi, s11, 0xffff
    ds_write_b128 v118, v[92:95] offset:2560
    ds_write_b128 v118, v[96:99] offset:2816
    v_and_b32 v116, 0x7f, v114
    v_mad_u32_u24 v118, v116, s75, v22
    s_cmp_lg_u32 s80, 0
    ds_read_b128 v[100:103], v118 offset:3072
    ds_read_b128 v[92:95], v22 offset:1536
    ds_read_b128 v[96:99], v22 offset:2048
    s_mov_b64 exec, -1
    s_cbranch_scc1 K2_BK_0_2
    s_branch K2_LOOP_DONE
K2_FL_0_3:
    s_mul_i32 exec_lo, s10, 0xffff
    s_mul_i32 exec_hi, s11, 0xffff
    ds_write_b128 v118, v[92:95] offset:2560
    ds_write_b128 v118, v[96:99] offset:2816
    v_and_b32 v116, 0x7f, v108
    v_mad_u32_u24 v118, v116, s75, v22
    s_cmp_lg_u32 s80, 0
    ds_read_b128 v[100:103], v118 offset:3072
    ds_read_b128 v[92:95], v22 offset:1536
    ds_read_b128 v[96:99], v22 offset:2048
    s_mov_b64 exec, -1
    s_cbranch_scc1 K2_BK_0_3
K2_LOOP_DONE:
    s_setprio 0
    v_cmp_gt_u32 s[10:11], s75, v0
    s_waitcnt vmcnt(0) lgkmcnt(0)
    s_barrier
    s_mov_b64 exec, s[10:11]
    ds_read_b128 v[40:43], v19 offset:256
    ds_read_b128 v[72:75], v6 offset:256
    ds_read_b128 v[44:47], v19 offset:272
    ds_read_b128 v[76:79], v6 offset:272
    ds_read_b128 v[32:35], v19
    ds_read_b128 v[64:67], v6
    ds_read_b128 v[36:39], v19 offset:16
    ds_read_b128 v[68:71], v6 offset:16
    v_cmp_lt_u32 vcc, 1, v7
    s_or_b32 s3, s81, s74
    s_cselect_b64 s[4:5], -1, vcc
    s_waitcnt lgkmcnt(4)
    v_pk_add_f32 v[40:41], v[40:41], v[72:73]
    v_pk_add_f32 v[42:43], v[42:43], v[74:75]
    v_pk_add_f32 v[44:45], v[44:45], v[76:77]
    v_pk_add_f32 v[46:47], v[46:47], v[78:79]
    s_cmp_lg_u64 s[4:5], 0
    s_cbranch_scc1 K2_RARE_FIN
    v_rcp_f32 v40, v40
    v_rcp_f32 v41, v41
    v_rcp_f32 v42, v42
    v_rcp_f32 v43, v43
    v_rcp_f32 v44, v44
    v_rcp_f32 v45, v45
    v_rcp_f32 v46, v46
    v_rcp_f32 v47, v47
    s_waitcnt lgkmcnt(0)
    v_pk_add_f32 v[32:33], v[32:33], v[64:65]
    v_pk_add_f32 v[34:35], v[34:35], v[66:67]
    v_pk_add_f32 v[36:37], v[36:37], v[68:69]
    v_pk_add_f32 v[38:39], v[38:39], v[70:71]
K2_FINAL:
    v_pk_fma_f32 v[32:33], v[32:33], v[40:41], v[120:121]
    v_pk_fma_f32 v[34:35], v[34:35], v[42:43], v[122:123]
    v_pk_fma_f32 v[36:37], v[36:37], v[44:45], v[124:125]
    v_pk_fma_f32 v[38:39], v[38:39], v[46:47], v[126:127]
    v_max_f32 v32, v2, v32
    v_max_f32 v33, v3, v33
    v_max_f32 v34, v4, v34
    v_max_f32 v35, v5, v35
    v_max_f32 v36, v15, v36
    v_max_f32 v37, v16, v37
    v_max_f32 v38, v17, v38
    v_max_f32 v39, v18, v39
    v_cvt_pk_bf16_f32 v40, v32, v33
    v_cvt_pk_bf16_f32 v41, v34, v35
    v_cvt_pk_bf16_f32 v42, v36, v37
    v_cvt_pk_bf16_f32 v43, v38, v39
    buffer_store_dwordx4 v[40:43], v12, s[56:59], 0 offen sc1
K2_END:
    s_endpgm
K2_RMFIX:
    s_cmp_ge_u32 s78, 14
    s_cbranch_scc1 K2_NORM
    v_mov_b32 v4, 226492416
    v_mov_b32 v5, 226492416
    s_mov_b32 s18, 0x05040100
    v_pk_fma_f32 v[100:101], v[100:101], s[16:17], v[4:5]
    v_pk_fma_f32 v[102:103], v[102:103], s[16:17], v[4:5]
    v_pk_fma_f32 v[104:105], v[104:105], s[16:17], v[4:5]
    v_pk_fma_f32 v[106:107], v[106:107], s[16:17], v[4:5]
    v_sub_u32_sdwa v100, v100, v108 dst_sel:DWORD dst_unused:UNUSED_PAD src0_sel:DWORD src1_sel:WORD_0
    v_sub_u32_sdwa v101, v101, v108 dst_sel:DWORD dst_unused:UNUSED_PAD src0_sel:DWORD src1_sel:WORD_1
    v_cvt_pk_bf16_f32 v100, v100, v101
    v_perm_b32 v48, v100, v108, s18
    v_perm_b32 v49, v100, v108, s19
    v_sub_u32_sdwa v102, v102, v110 dst_sel:DWORD dst_unused:UNUSED_PAD src0_sel:DWORD src1_sel:WORD_0
    v_sub_u32_sdwa v103, v103, v110 dst_sel:DWORD dst_unused:UNUSED_PAD src0_sel:DWORD src1_sel:WORD_1
    v_cvt_pk_bf16_f32 v102, v102, v103
    v_perm_b32 v50, v102, v110, s18
    v_perm_b32 v51, v102, v110, s19
    v_sub_u32_sdwa v104, v104, v112 dst_sel:DWORD dst_unused:UNUSED_PAD src0_sel:DWORD src1_sel:WORD_0
    v_sub_u32_sdwa v105, v105, v112 dst_sel:DWORD dst_unused:UNUSED_PAD src0_sel:DWORD src1_sel:WORD_1
    v_cvt_pk_bf16_f32 v104, v104, v105
    v_perm_b32 v52, v104, v112, s18
    v_perm_b32 v53, v104, v112, s19
    v_sub_u32_sdwa v106, v106, v114 dst_sel:DWORD dst_unused:UNUSED_PAD src0_sel:DWORD src1_sel:WORD_0
    v_sub_u32_sdwa v107, v107, v114 dst_sel:DWORD dst_unused:UNUSED_PAD src0_sel:DWORD src1_sel:WORD_1
    v_cvt_pk_bf16_f32 v106, v106, v107
    v_perm_b32 v54, v106, v114, s18
    v_perm_b32 v55, v106, v114, s19
    s_lshr_b32 s3, s78, 1
    v_lshl_add_u32 v4, s3, 4, v7
    v_cmp_gt_u32 vcc, 98, v4
    s_mov_b64 exec, vcc
    ds_write_b128 v14, v[48:51] offset:3072
    ds_write_b128 v14, v[52:55] offset:3136
    s_mov_b64 exec, -1
    s_branch K2_NORM
K2_LOOP_1:
    s_waitcnt lgkmcnt(0)
    v_pk_add_f32 v[64:65], v[64:65], v[100:101]
    v_pk_add_f32 v[66:67], v[66:67], v[102:103]
    v_pk_add_f32 v[68:69], v[68:69], v[100:101]
    v_pk_add_f32 v[70:71], v[70:71], v[102:103]
    v_mfma_f32_16x16x32_bf16 v[72:75], v[28:31], v[32:35], 0
    v_exp_f32 v64, v64
    v_exp_f32 v65, v65
    v_mfma_f32_16x16x32_bf16 v[76:79], v[28:31], v[36:39], 0
    v_exp_f32 v66, v66
    v_exp_f32 v67, v67
    v_exp_f32 v68, v68
    v_exp_f32 v69, v69
    v_exp_f32 v70, v70
    v_exp_f32 v71, v71
    s_waitcnt lgkmcnt(0)
    v_and_or_b32 v116, v108, s12, v22
    v_and_or_b32 v117, v109, s12, v22
    buffer_load_dwordx4 v[32:35], v116, s[40:43], 0 offen
    buffer_load_dwordx4 v[36:39], v117, s[40:43], 0 offen
    v_pk_fma_f32 v[64:65], v[64:65], v[26:27], v[26:27] clamp
    v_pk_fma_f32 v[66:67], v[66:67], v[26:27], v[26:27] clamp
    v_pk_fma_f32 v[68:69], v[68:69], v[26:27], v[26:27] clamp
    v_pk_fma_f32 v[70:71], v[70:71], v[26:27], v[26:27] clamp
    v_pk_mul_f32 v[80:81], v[64:65], v[68:69]
    v_pk_mul_f32 v[82:83], v[66:67], v[70:71]
    v_pk_add_f32 v[84:85], v[64:65], v[68:69]
    v_pk_add_f32 v[86:87], v[66:67], v[70:71]
    v_pk_mul_f32 v[88:89], v[72:73], v[68:69]
    v_pk_mul_f32 v[90:91], v[74:75], v[70:71]
    v_pk_fma_f32 v[88:89], v[76:77], v[64:65], v[88:89]
    v_pk_fma_f32 v[90:91], v[78:79], v[66:67], v[90:91]
    s_waitcnt vmcnt(6)
    v_mfma_f32_16x16x16_bf16 v[64:67], v[104:105], v[24:25], v[40:43]
    v_rcp_f32 v80, v80
    v_rcp_f32 v81, v81
    v_mfma_f32_16x16x16_bf16 v[68:71], v[106:107], v[24:25], v[44:47]
    v_rcp_f32 v82, v82
    v_rcp_f32 v83, v83
    s_and_b64 s[10:11], s[4:5], s[8:9]
    v_pk_fma_f32 v[96:97], v[84:85], v[80:81], v[96:97]
    v_pk_fma_f32 v[98:99], v[86:87], v[82:83], v[98:99]
    v_pk_fma_f32 v[92:93], v[88:89], v[80:81], v[92:93]
    v_pk_fma_f32 v[94:95], v[90:91], v[82:83], v[94:95]
    s_cbranch_scc1 K2_FL_1_0
K2_BK_1_0:
    ds_read_b64 v[110:111], v119 offset:40
    ds_read_b128 v[104:107], v20 offset:1568
    s_lshr_b64 s[4:5], s[4:5], 1
    s_sub_u32 s80, s80, 1
    s_cmp_gt_u32 s80, 3
    s_cselect_b32 s42, 3200256, 0
    s_waitcnt lgkmcnt(0)
    v_pk_add_f32 v[64:65], v[64:65], v[100:101]
    v_pk_add_f32 v[66:67], v[66:67], v[102:103]
    v_pk_add_f32 v[68:69], v[68:69], v[100:101]
    v_pk_add_f32 v[70:71], v[70:71], v[102:103]
    v_mfma_f32_16x16x32_bf16 v[72:75], v[28:31], v[40:43], 0
    v_exp_f32 v64, v64
    v_exp_f32 v65, v65
    v_mfma_f32_16x16x32_bf16 v[76:79], v[28:31], v[44:47], 0
    v_exp_f32 v66, v66
    v_exp_f32 v67, v67
    v_exp_f32 v68, v68
    v_exp_f32 v69, v69
    v_exp_f32 v70, v70
    v_exp_f32 v71, v71
    s_waitcnt lgkmcnt(0)
    v_and_or_b32 v116, v110, s12, v22
    v_and_or_b32 v117, v111, s12, v22
    buffer_load_dwordx4 v[40:43], v116, s[40:43], 0 offen
    buffer_load_dwordx4 v[44:47], v117, s[40:43], 0 offen
    v_pk_fma_f32 v[64:65], v[64:65], v[26:27], v[26:27] clamp
    v_pk_fma_f32 v[66:67], v[66:67], v[26:27], v[26:27] clamp
    v_pk_fma_f32 v[68:69], v[68:69], v[26:27], v[26:27] clamp
    v_pk_fma_f32 v[70:71], v[70:71], v[26:27], v[26:27] clamp
    v_pk_mul_f32 v[80:81], v[64:65], v[68:69]
    v_pk_mul_f32 v[82:83], v[66:67], v[70:71]
    v_pk_add_f32 v[84:85], v[64:65], v[68:69]
    v_pk_add_f32 v[86:87], v[66:67], v[70:71]
    v_pk_mul_f32 v[88:89], v[72:73], v[68:69]
    v_pk_mul_f32 v[90:91], v[74:75], v[70:71]
    v_pk_fma_f32 v[88:89], v[76:77], v[64:65], v[88:89]
    v_pk_fma_f32 v[90:91], v[78:79], v[66:67], v[90:91]
    s_waitcnt vmcnt(6)
    v_mfma_f32_16x16x16_bf16 v[64:67], v[104:105], v[24:25], v[48:51]
    v_rcp_f32 v80, v80
    v_rcp_f32 v81, v81
    v_mfma_f32_16x16x16_bf16 v[68:71], v[106:107], v[24:25], v[52:55]
    v_rcp_f32 v82, v82
    v_rcp_f32 v83, v83
    s_and_b64 s[10:11], s[4:5], s[8:9]
    v_pk_fma_f32 v[96:97], v[84:85], v[80:81], v[96:97]
    v_pk_fma_f32 v[98:99], v[86:87], v[82:83], v[98:99]
    v_pk_fma_f32 v[92:93], v[88:89], v[80:81], v[92:93]
    v_pk_fma_f32 v[94:95], v[90:91], v[82:83], v[94:95]
    s_cbranch_scc1 K2_FL_1_1
K2_BK_1_1:
    ds_read_b64 v[112:113], v119 offset:48
    ds_read_b128 v[104:107], v20 offset:1584
    s_lshr_b64 s[4:5], s[4:5], 1
    s_sub_u32 s80, s80, 1
    s_cmp_gt_u32 s80, 3
    s_cselect_b32 s42, 3200256, 0
    s_waitcnt lgkmcnt(0)
    v_pk_add_f32 v[64:65], v[64:65], v[100:101]
    v_pk_add_f32 v[66:67], v[66:67], v[102:103]
    v_pk_add_f32 v[68:69], v[68:69], v[100:101]
    v_pk_add_f32 v[70:71], v[70:71], v[102:103]
    v_mfma_f32_16x16x32_bf16 v[72:75], v[28:31], v[48:51], 0
    v_exp_f32 v64, v64
    v_exp_f32 v65, v65
    v_mfma_f32_16x16x32_bf16 v[76:79], v[28:31], v[52:55], 0
    v_exp_f32 v66, v66
    v_exp_f32 v67, v67
    v_exp_f32 v68, v68
    v_exp_f32 v69, v69
    v_exp_f32 v70, v70
    v_exp_f32 v71, v71
    s_waitcnt lgkmcnt(0)
    v_and_or_b32 v116, v112, s12, v22
    v_and_or_b32 v117, v113, s12, v22
    buffer_load_dwordx4 v[48:51], v116, s[40:43], 0 offen
    buffer_load_dwordx4 v[52:55], v117, s[40:43], 0 offen
    v_pk_fma_f32 v[64:65], v[64:65], v[26:27], v[26:27] clamp
    v_pk_fma_f32 v[66:67], v[66:67], v[26:27], v[26:27] clamp
    v_pk_fma_f32 v[68:69], v[68:69], v[26:27], v[26:27] clamp
    v_pk_fma_f32 v[70:71], v[70:71], v[26:27], v[26:27] clamp
    v_pk_mul_f32 v[80:81], v[64:65], v[68:69]
    v_pk_mul_f32 v[82:83], v[66:67], v[70:71]
    v_pk_add_f32 v[84:85], v[64:65], v[68:69]
    v_pk_add_f32 v[86:87], v[66:67], v[70:71]
    v_pk_mul_f32 v[88:89], v[72:73], v[68:69]
    v_pk_mul_f32 v[90:91], v[74:75], v[70:71]
    v_pk_fma_f32 v[88:89], v[76:77], v[64:65], v[88:89]
    v_pk_fma_f32 v[90:91], v[78:79], v[66:67], v[90:91]
    s_waitcnt vmcnt(6)
    v_mfma_f32_16x16x16_bf16 v[64:67], v[104:105], v[24:25], v[56:59]
    v_rcp_f32 v80, v80
    v_rcp_f32 v81, v81
    v_mfma_f32_16x16x16_bf16 v[68:71], v[106:107], v[24:25], v[60:63]
    v_rcp_f32 v82, v82
    v_rcp_f32 v83, v83
    s_and_b64 s[10:11], s[4:5], s[8:9]
    v_pk_fma_f32 v[96:97], v[84:85], v[80:81], v[96:97]
    v_pk_fma_f32 v[98:99], v[86:87], v[82:83], v[98:99]
    v_pk_fma_f32 v[92:93], v[88:89], v[80:81], v[92:93]
    v_pk_fma_f32 v[94:95], v[90:91], v[82:83], v[94:95]
    s_cbranch_scc1 K2_FL_1_2
K2_BK_1_2:
    ds_read_b64 v[114:115], v119 offset:56
    ds_read_b128 v[104:107], v20 offset:1600
    s_lshr_b64 s[4:5], s[4:5], 1
    s_sub_u32 s80, s80, 1
    s_cmp_gt_u32 s80, 3
    s_cselect_b32 s42, 3200256, 0
    s_waitcnt lgkmcnt(0)
    v_pk_add_f32 v[64:65], v[64:65], v[100:101]
    v_pk_add_f32 v[66:67], v[66:67], v[102:103]
    v_pk_add_f32 v[68:69], v[68:69], v[100:101]
    v_pk_add_f32 v[70:71], v[70:71], v[102:103]
    v_mfma_f32_16x16x32_bf16 v[72:75], v[28:31], v[56:59], 0
    v_exp_f32 v64, v64
    v_exp_f32 v65, v65
    v_mfma_f32_16x16x32_bf16 v[76:79], v[28:31], v[60:63], 0
    v_exp_f32 v66, v66
    v_exp_f32 v67, v67
    v_exp_f32 v68, v68
    v_exp_f32 v69, v69
    v_exp_f32 v70, v70
    v_exp_f32 v71, v71
    s_waitcnt lgkmcnt(0)
    v_and_or_b32 v116, v114, s12, v22
    v_and_or_b32 v117, v115, s12, v22
    buffer_load_dwordx4 v[56:59], v116, s[40:43], 0 offen
    buffer_load_dwordx4 v[60:63], v117, s[40:43], 0 offen
    v_pk_fma_f32 v[64:65], v[64:65], v[26:27], v[26:27] clamp
    v_pk_fma_f32 v[66:67], v[66:67], v[26:27], v[26:27] clamp
    v_pk_fma_f32 v[68:69], v[68:69], v[26:27], v[26:27] clamp
    v_pk_fma_f32 v[70:71], v[70:71], v[26:27], v[26:27] clamp
    v_pk_mul_f32 v[80:81], v[64:65], v[68:69]
    v_pk_mul_f32 v[82:83], v[66:67], v[70:71]
    v_pk_add_f32 v[84:85], v[64:65], v[68:69]
    v_pk_add_f32 v[86:87], v[66:67], v[70:71]
    v_pk_mul_f32 v[88:89], v[72:73], v[68:69]
    v_pk_mul_f32 v[90:91], v[74:75], v[70:71]
    v_pk_fma_f32 v[88:89], v[76:77], v[64:65], v[88:89]
    v_pk_fma_f32 v[90:91], v[78:79], v[66:67], v[90:91]
    s_waitcnt vmcnt(6)
    v_mfma_f32_16x16x16_bf16 v[64:67], v[104:105], v[24:25], v[32:35]
    v_rcp_f32 v80, v80
    v_rcp_f32 v81, v81
    v_mfma_f32_16x16x16_bf16 v[68:71], v[106:107], v[24:25], v[36:39]
    v_rcp_f32 v82, v82
    v_rcp_f32 v83, v83
    s_and_b64 s[10:11], s[4:5], s[8:9]
    v_pk_fma_f32 v[96:97], v[84:85], v[80:81], v[96:97]
    v_pk_fma_f32 v[98:99], v[86:87], v[82:83], v[98:99]
    v_pk_fma_f32 v[92:93], v[88:89], v[80:81], v[92:93]
    v_pk_fma_f32 v[94:95], v[90:91], v[82:83], v[94:95]
    s_cbranch_scc1 K2_FL_1_3
K2_BK_1_3:
    ds_read_b64 v[108:109], v119 offset:64
    ds_read_b128 v[104:107], v20 offset:1616
    s_lshr_b64 s[4:5], s[4:5], 1
    s_sub_u32 s80, s80, 1
    s_cmp_gt_u32 s80, 3
    s_cselect_b32 s42, 3200256, 0
    v_add_u32 v119, 32, v119
    v_add_u32 v20, v21, v20
    s_cmp_eq_u32 s80, s83
    s_cselect_b64 s[4:5], s[6:7], s[4:5]
    s_cmp_ge_u32 s80, 16
    s_cbranch_scc1 K2_LOOP_1
    s_setprio 2
    s_cmp_ge_u32 s80, 8
    s_cbranch_scc1 K2_LOOP_1
    s_setprio 1
    s_cmp_ge_u32 s80, 4
    s_cbranch_scc1 K2_LOOP_1
    s_setprio 0
    s_branch K2_LOOP_1
K2_FL_1_0:
    s_mul_i32 exec_lo, s10, 0xffff
    s_mul_i32 exec_hi, s11, 0xffff
    ds_write_b128 v118, v[92:95] offset:2560
    ds_write_b128 v118, v[96:99] offset:2816
    v_and_b32 v116, 0x7f, v110
    v_mad_u32_u24 v118, v116, s75, v22
    s_cmp_lg_u32 s80, 0
    ds_read_b128 v[100:103], v118 offset:3072
    ds_read_b128 v[92:95], v22 offset:1536
    ds_read_b128 v[96:99], v22 offset:2048
    s_mov_b64 exec, -1
    s_cbranch_scc1 K2_BK_1_0
    s_branch K2_LOOP_DONE
K2_FL_1_1:
    s_mul_i32 exec_lo, s10, 0xffff
    s_mul_i32 exec_hi, s11, 0xffff
    ds_write_b128 v118, v[92:95] offset:2560
    ds_write_b128 v118, v[96:99] offset:2816
    v_and_b32 v116, 0x7f, v112
    v_mad_u32_u24 v118, v116, s75, v22
    s_cmp_lg_u32 s80, 0
    ds_read_b128 v[100:103], v118 offset:3072
    ds_read_b128 v[92:95], v22 offset:1536
    ds_read_b128 v[96:99], v22 offset:2048
    s_mov_b64 exec, -1
    s_cbranch_scc1 K2_BK_1_1
    s_branch K2_LOOP_DONE
K2_FL_1_2:
    s_mul_i32 exec_lo, s10, 0xffff
    s_mul_i32 exec_hi, s11, 0xffff
    ds_write_b128 v118, v[92:95] offset:2560
    ds_write_b128 v118, v[96:99] offset:2816
    v_and_b32 v116, 0x7f, v114
    v_mad_u32_u24 v118, v116, s75, v22
    s_cmp_lg_u32 s80, 0
    ds_read_b128 v[100:103], v118 offset:3072
    ds_read_b128 v[92:95], v22 offset:1536
    ds_read_b128 v[96:99], v22 offset:2048
    s_mov_b64 exec, -1
    s_cbranch_scc1 K2_BK_1_2
    s_branch K2_LOOP_DONE
K2_FL_1_3:
    s_mul_i32 exec_lo, s10, 0xffff
    s_mul_i32 exec_hi, s11, 0xffff
    ds_write_b128 v118, v[92:95] offset:2560
    ds_write_b128 v118, v[96:99] offset:2816
    v_and_b32 v116, 0x7f, v108
    v_mad_u32_u24 v118, v116, s75, v22
    s_cmp_lg_u32 s80, 0
    ds_read_b128 v[100:103], v118 offset:3072
    ds_read_b128 v[92:95], v22 offset:1536
    ds_read_b128 v[96:99], v22 offset:2048
    s_mov_b64 exec, -1
    s_cbranch_scc1 K2_BK_1_3
    s_branch K2_LOOP_DONE
K2_SLOWINIT:
    s_cmp_lg_u32 s81, 0
    s_cbranch_scc1 K2_DECIDED
    v_lshl_add_u32 v2, v1, 3, s13
    buffer_load_dwordx2 v[2:3], v2, s[28:31], 0 offen
    s_waitcnt vmcnt(0)
    v_lshrrev_b32 v2, 16, v2
    v_lshrrev_b32 v3, 16, v3
    v_max_u32 v2, v2, v3
    s_nop 1
    v_max_u32_dpp v2, v2, v2 row_shr:1 row_mask:0xf bank_mask:0xf bound_ctrl:1
    s_nop 1
    v_max_u32_dpp v2, v2, v2 row_shr:2 row_mask:0xf bank_mask:0xf bound_ctrl:1
    s_nop 1
    v_max_u32_dpp v2, v2, v2 row_shr:4 row_mask:0xf bank_mask:0xf bound_ctrl:1
    s_nop 1
    v_max_u32_dpp v2, v2, v2 row_shr:8 row_mask:0xf bank_mask:0xf bound_ctrl:1
    s_nop 1
    v_max_u32_dpp v2, v2, v2 row_bcast:15 row_mask:0xa bank_mask:0xf
    s_nop 1
    v_max_u32_dpp v2, v2, v2 row_bcast:31 row_mask:0xc bank_mask:0xf
    s_nop 0
    v_readlane_b32 s3, v2, 63
    s_add_u32 s3, s3, 23
    s_mul_i32 s3, s3, 43691
    s_lshr_b32 s81, s3, 20
    s_mov_b64 s[66:67], 0
    s_mov_b64 s[68:69], 0
    s_mov_b64 s[70:71], 0
    s_mov_b64 s[72:73], 0
    s_barrier
    v_mov_b32 v2, 0
    v_mov_b32 v3, 0
    ds_write_b64 v13, v[2:3]
    s_waitcnt lgkmcnt(0)
    s_barrier
    s_branch K2_BATCH
K2_RARE_FIN:
    s_waitcnt lgkmcnt(0)
    v_pk_add_f32 v[32:33], v[32:33], v[64:65]
    v_pk_add_f32 v[34:35], v[34:35], v[66:67]
    v_pk_add_f32 v[36:37], v[36:37], v[68:69]
    v_pk_add_f32 v[38:39], v[38:39], v[70:71]
    s_cbranch_vccz K2_HEADS_DONE
K2_MORE_HEADS:
    s_mov_b64 exec, vcc
    v_add_u32 v14, 512, v14
    v_subrev_u32 v7, 1, v7
    ds_read_b128 v[64:67], v14
    ds_read_b128 v[68:71], v14 offset:16
    ds_read_b128 v[72:75], v14 offset:256
    ds_read_b128 v[76:79], v14 offset:272
    v_cmp_lt_u32 vcc, 1, v7
    s_waitcnt lgkmcnt(0)
    v_pk_add_f32 v[32:33], v[32:33], v[64:65]
    v_pk_add_f32 v[34:35], v[34:35], v[66:67]
    v_pk_add_f32 v[36:37], v[36:37], v[68:69]
    v_pk_add_f32 v[38:39], v[38:39], v[70:71]
    v_pk_add_f32 v[40:41], v[40:41], v[72:73]
    v_pk_add_f32 v[42:43], v[42:43], v[74:75]
    v_pk_add_f32 v[44:45], v[44:45], v[76:77]
    v_pk_add_f32 v[46:47], v[46:47], v[78:79]
    s_cbranch_vccnz K2_MORE_HEADS
    s_mov_b64 exec, s[10:11]
K2_HEADS_DONE:
    s_cmp_eq_u32 s81, 0
    s_cbranch_scc1 K2_RCP
    s_sub_u32 s81, s81, 1
    s_lshl_b32 s3, s2, 16
    s_add_u32 s3, s3, 17825792
    v_lshl_add_u32 v48, v0, 6, s3
    s_cmp_eq_u32 s74, 0
    s_cbranch_scc1 K2_NOLOAD
    buffer_load_dwordx4 v[64:67], v48, s[28:31], 0 offen offset:0
    buffer_load_dwordx4 v[68:71], v48, s[28:31], 0 offen offset:16
    buffer_load_dwordx4 v[72:75], v48, s[28:31], 0 offen offset:32
    buffer_load_dwordx4 v[76:79], v48, s[28:31], 0 offen offset:48
    s_waitcnt vmcnt(0)
    v_pk_add_f32 v[32:33], v[32:33], v[64:65]
    v_pk_add_f32 v[34:35], v[34:35], v[66:67]
    v_pk_add_f32 v[36:37], v[36:37], v[68:69]
    v_pk_add_f32 v[38:39], v[38:39], v[70:71]
    v_pk_add_f32 v[40:41], v[40:41], v[72:73]
    v_pk_add_f32 v[42:43], v[42:43], v[74:75]
    v_pk_add_f32 v[44:45], v[44:45], v[76:77]
    v_pk_add_f32 v[46:47], v[46:47], v[78:79]
K2_NOLOAD:
    s_cmp_lg_u32 s81, 0
    s_cbranch_scc1 K2_NEXT
K2_RCP:
    v_rcp_f32 v40, v40
    v_rcp_f32 v41, v41
    v_rcp_f32 v42, v42
    v_rcp_f32 v43, v43
    v_rcp_f32 v44, v44
    v_rcp_f32 v45, v45
    v_rcp_f32 v46, v46
    v_rcp_f32 v47, v47
    s_nop 0
    s_branch K2_FINAL
K2_NEXT:
    s_mov_b32 s22, 1418082237
    s_mov_b32 s23, 1418082237
    v_pk_add_f32 v[40:41], v[40:41], s[22:23] neg_lo:[0,1] neg_hi:[0,1]
    v_pk_add_f32 v[42:43], v[42:43], s[22:23] neg_lo:[0,1] neg_hi:[0,1]
    v_pk_add_f32 v[44:45], v[44:45], s[22:23] neg_lo:[0,1] neg_hi:[0,1]
    v_pk_add_f32 v[46:47], v[46:47], s[22:23] neg_lo:[0,1] neg_hi:[0,1]
    buffer_store_dwordx4 v[32:35], v48, s[28:31], 0 offen offset:0
    buffer_store_dwordx4 v[36:39], v48, s[28:31], 0 offen offset:16
    buffer_store_dwordx4 v[40:43], v48, s[28:31], 0 offen offset:32
    buffer_store_dwordx4 v[44:47], v48, s[28:31], 0 offen offset:48
    s_mov_b64 exec, -1
    s_waitcnt vmcnt(0) lgkmcnt(0)
    s_barrier
    v_lshrrev_b32 v2, 3, v0
    v_lshl_add_u32 v3, v2, 2, s13
    buffer_load_dword v116, v3, s[28:31], 0 offen
    s_add_u32 s74, s74, 24
    s_mov_b32 s3, 37536
    v_mul_u32_u24 v117, s3, v2
    v_and_b32 v15, 7, v0
    v_add_u32 v15, s74, v15
    v_mad_u32_u24 v117, v15, 12, v117
    v_add_u32 v117, 8388608, v117
    v_mov_b32 v118, 4
    v_mov_b32 v19, 0
    v_lshrrev_b32 v6, 4, v1
    v_and_b32 v7, 15, v1
    s_lshl_b32 s3, s78, 2
    v_bfe_u32 v16, v1, 2, 2
    v_add_u32 v119, s3, v6
    v_add_u32 v20, s3, v16
    v_mov_b32 v2, 0
    v_mov_b32 v3, 0
    ds_write_b64 v13, v[2:3]
    s_mov_b32 s42, 3200256
    s_cmp_eq_u32 s82, 0
    s_cbranch_scc1 K2_NB_NOFLAG
    v_mov_b32 v5, 5
    ds_write_b32 v19, v5 offset:2304
K2_NB_NOFLAG:
    s_waitcnt vmcnt(0)
    v_and_b32 v3, 0xffff, v116
    v_lshrrev_b32 v116, 16, v116
    v_add_u32 v117, v3, v117
    v_sub_u32 v116, v116, v15
    v_cmp_lt_i32 s[60:61], 0, v116
    v_cmp_lt_i32 s[62:63], 8, v116
    v_cmp_lt_i32 s[64:65], 16, v116
    s_mov_b64 exec, s[60:61]
    buffer_load_dwordx3 v[64:66], v117, s[28:31], 0 offen offset:0
    s_mov_b64 exec, s[62:63]
    buffer_load_dwordx3 v[68:70], v117, s[28:31], 0 offen offset:96
    s_mov_b64 exec, s[64:65]
    buffer_load_dwordx3 v[72:74], v117, s[28:31], 0 offen offset:192
K2_RI_SLOW:
    s_mov_b64 exec, -1
    s_waitcnt vmcnt(0) lgkmcnt(0)
    s_barrier
    s_branch K2_BATCH
CODE_END:
.section .rodata,"a"
.p2align 6
.amdhsa_kernel prep_kernel
  .amdhsa_next_free_vgpr 128
  .amdhsa_next_free_sgpr 64
  .amdhsa_accum_offset 128
  .amdhsa_group_segment_fixed_size 0
  .amdhsa_kernarg_size 96
  .amdhsa_user_sgpr_count 2
  .amdhsa_user_sgpr_kernarg_segment_ptr 1
  .amdhsa_system_sgpr_workgroup_id_x 1
.end_amdhsa_kernel
.p2align 6
.amdhsa_kernel agg_kernel
  .amdhsa_next_free_vgpr 128
  .amdhsa_next_free_sgpr 84
  .amdhsa_accum_offset 128
  .amdhsa_group_segment_fixed_size 0
  .amdhsa_kernarg_size 96
  .amdhsa_user_sgpr_count 2
  .amdhsa_user_sgpr_kernarg_segment_ptr 1
  .amdhsa_system_sgpr_workgroup_id_x 1
.end_amdhsa_kernel
```
